```python
import torch

def _softmax(x, axis=-1):
    return torch.softmax(x, dim=axis)
def _gelu(x):
    return torch.nn.functional.gelu(x, approximate="tanh")
def _silu(x):
    return torch.nn.functional.silu(x)
def _sigmoid(x):
    return torch.sigmoid(x)
def _layernorm(x, axis=-1, eps=1e-5):
    m = x.mean(dim=axis, keepdim=True)
    v = x.var(dim=axis, keepdim=True, unbiased=False)
    return (x - m) / torch.sqrt(v + eps)
def _scatter_add(tgt, idx, src, axis=0):
    return tgt.clone().index_add_(axis, idx, src)
def _segment_sum(src, seg, n):
    out = torch.zeros((n,) + src.shape[1:], dtype=src.dtype)
    return out.index_add_(0, seg, src)
def _pad(x, pw):
    flat = tuple(v for pair in reversed(pw) for v in pair)
    return torch.nn.functional.pad(x, flat)

kernel_name = 'standalone__linear_kernel_rfa__decode'

def setup_inputs():

    _w = (lambda a: (lambda t: t.to(torch.bfloat16) if t.is_floating_point() else t)(torch.as_tensor(a)))
    B, H, Sq, Sk, D, M = 1, 16, 1, 32768, 256, 8
    return {
        "q": _w((lambda *s: torch.randn(*s, dtype=torch.bfloat16) * 0.4)(B, H, Sq, D)),
        "k": _w((lambda *s: torch.randn(*s, dtype=torch.bfloat16) * 1.6)(B, H, Sk, D)),
        "v": _w((lambda *s: torch.randn(*s, dtype=torch.bfloat16) * 1.6)(B, H, Sk, D)),
        "omega": _w((lambda *s: torch.randn(*s, dtype=torch.bfloat16) * 1.6)(M, D)),
    }

def reference(q, k, v, omega):
    d = q.shape[-1]
    m = omega.shape[0]
    scale = float(d) ** -0.25
    qs = q * scale
    ks = k * scale
    q_proj = torch.einsum("bhsd,md->bhsm", qs, omega)
    k_proj = torch.einsum("bhsd,md->bhsm", ks, omega)
    q_sq = 0.5 * torch.einsum("bhsd,bhsd->bhs", qs, qs)[..., None]
    k_sq = 0.5 * torch.einsum("bhsd,bhsd->bhs", ks, ks)[..., None]
    inv_sqrt_m = float(m) ** -0.5
    phi_q = torch.exp(q_proj - q_sq) * inv_sqrt_m + 1e-6
    phi_k = torch.exp(k_proj - k_sq) * inv_sqrt_m + 1e-6
    kv = torch.einsum("bhsm,bhsd->bhmd", phi_k, v)
    z  = torch.einsum("bhsm->bhm", phi_k)
    num = torch.einsum("bhqm,bhmd->bhqd", phi_q, kv)
    den = torch.einsum("bhqm,bhm->bhq", phi_q, z)[..., None] + 1e-6
    return num / den
```

```asm
; @launch grid=(256,1,1) block=(128,1,1) lds=131072
.amdgcn_target "amdgcn-amd-amdhsa--gfx950"
.text
.globl standalone__linear_kernel_rfa__decode_kernel
.p2align 8
.type standalone__linear_kernel_rfa__decode_kernel,@function
standalone__linear_kernel_rfa__decode_kernel:
    s_cmp_ge_u32 s2, 256
    s_cbranch_scc1 L_end_standalone__linear_kernel_rfa__decode_kernel
    s_load_dwordx8 s[48:55], s[0:1], 0
    s_load_dwordx4 s[56:59], s[0:1], 32
    s_load_dwordx2 s[62:63], s[0:1], 48
    v_lshrrev_b32 v24, 6, v0
    v_and_b32 v6, 63, v0
    s_lshr_b32 s38, s2, 4
    s_lshl_b32 s39, s38, 24
    v_readfirstlane_b32 s19, v24
    v_lshrrev_b32 v24, 5, v6
    v_and_b32 v25, 31, v6
    v_lshlrev_b32 v26, 3, v24
    v_xor_b32 v25, v25, v26
    v_lshlrev_b32 v24, 9, v24
    v_xor_b32 v26, 0, v25
    v_lshl_add_u32 v56, v26, 4, v24
    v_xor_b32 v26, 1, v25
    v_lshl_add_u32 v57, v26, 4, v24
    v_xor_b32 v26, 2, v25
    v_lshl_add_u32 v58, v26, 4, v24
    v_add_u32 v58, 2048, v58
    v_xor_b32 v26, 3, v25
    v_lshl_add_u32 v59, v26, 4, v24
    v_add_u32 v59, 2048, v59
    v_xor_b32 v26, 4, v25
    v_lshl_add_u32 v60, v26, 4, v24
    v_add_u32 v60, 4096, v60
    v_xor_b32 v26, 5, v25
    v_lshl_add_u32 v61, v26, 4, v24
    v_add_u32 v61, 4096, v61
    v_xor_b32 v26, 6, v25
    v_lshl_add_u32 v62, v26, 4, v24
    v_add_u32 v62, 6144, v62
    v_xor_b32 v26, 7, v25
    v_lshl_add_u32 v63, v26, 4, v24
    v_add_u32 v63, 6144, v63
    s_bfe_u32 s3, s2, 0x10000
    s_lshl_b32 s3, s3, 14
    s_add_u32 s39, s39, s3
    s_bfe_u32 s3, s2, 0x20001
    s_lshl_b32 s3, s3, 22
    s_add_u32 s39, s39, s3
    s_bfe_u32 s3, s2, 0x10003
    s_lshl_b32 s3, s3, 21
    s_add_u32 s39, s39, s3
    s_mul_i32 s60, s19, 32768
    s_mov_b32 s17, 0
    s_mov_b32 s10, 0x10000000
    s_mov_b32 s11, 0x20000
    s_mov_b32 s14, 0x10000000
    s_mov_b32 s15, 0x20000
    s_mov_b32 s42, 4096
    s_mov_b32 s43, 0x20000
    s_mov_b32 s46, 8192
    s_mov_b32 s47, 0x20000
    s_and_b32 s16, s17, 63
    s_lshl_b32 s16, s16, 15
    s_add_u32 s16, s16, s39
    s_xor_b32 s3, s17, s19
    s_and_b32 s3, s3, 1
    s_lshl_b32 s3, s3, 13
    s_add_u32 s16, s16, s3
    s_add_u32 s17, s17, 1
    s_waitcnt lgkmcnt(0)
    s_mov_b32 s8, s50
    s_mov_b32 s9, s51
    s_add_u32 m0, s60, 0
    s_nop 0
    buffer_load_dwordx4 v56, s[8:11], s16 offen offset:0 sc1 nt lds
    buffer_load_dwordx4 v57, s[8:11], s16 offen offset:1024 sc1 nt lds
    s_load_dword s61, s[54:55], 0
    s_load_dword s61, s[48:49], 0
    s_load_dword s61, s[52:53], s39
    s_add_u32 m0, s60, 2048
    s_nop 0
    buffer_load_dwordx4 v58, s[8:11], s16 offen offset:0 sc1 nt lds
    buffer_load_dwordx4 v59, s[8:11], s16 offen offset:1024 sc1 nt lds
    s_add_u32 m0, s60, 4096
    s_nop 0
    buffer_load_dwordx4 v60, s[8:11], s16 offen offset:0 sc1 nt lds
    buffer_load_dwordx4 v61, s[8:11], s16 offen offset:1024 sc1 nt lds
    s_add_u32 m0, s60, 6144
    s_nop 0
    buffer_load_dwordx4 v62, s[8:11], s16 offen offset:0 sc1 nt lds
    buffer_load_dwordx4 v63, s[8:11], s16 offen offset:1024 sc1 nt lds
    s_mov_b32 s40, s54
    s_mov_b32 s41, s55
    s_mov_b32 s44, s48
    s_mov_b32 s45, s49
    s_lshl_b32 s3, s38, 9
    v_lshrrev_b32 v27, 4, v6
    v_lshlrev_b32 v28, 4, v27
    v_and_b32 v24, 7, v6
    v_lshl_add_u32 v25, v24, 9, v28
    buffer_load_dwordx4 a[32:35], v25, s[40:43], 0 offen offset:0
    buffer_load_dwordx4 a[36:39], v25, s[40:43], 0 offen offset:64
    buffer_load_dwordx4 a[40:43], v25, s[40:43], 0 offen offset:128
    buffer_load_dwordx4 a[44:47], v25, s[40:43], 0 offen offset:192
    buffer_load_dwordx4 a[48:51], v25, s[40:43], 0 offen offset:256
    buffer_load_dwordx4 a[52:55], v25, s[40:43], 0 offen offset:320
    buffer_load_dwordx4 a[56:59], v25, s[40:43], 0 offen offset:384
    buffer_load_dwordx4 a[60:63], v25, s[40:43], 0 offen offset:448
    buffer_load_dwordx4 a[64:67], v28, s[44:47], s3 offen offset:0
    buffer_load_dwordx4 a[68:71], v28, s[44:47], s3 offen offset:64
    buffer_load_dwordx4 a[72:75], v28, s[44:47], s3 offen offset:128
    buffer_load_dwordx4 a[76:79], v28, s[44:47], s3 offen offset:192
    buffer_load_dwordx4 a[80:83], v28, s[44:47], s3 offen offset:256
    buffer_load_dwordx4 a[84:87], v28, s[44:47], s3 offen offset:320
    buffer_load_dwordx4 a[88:91], v28, s[44:47], s3 offen offset:384
    buffer_load_dwordx4 a[92:95], v28, s[44:47], s3 offen offset:448
    s_and_b32 s16, s17, 63
    s_lshl_b32 s16, s16, 15
    s_add_u32 s16, s16, s39
    s_xor_b32 s3, s17, s19
    s_and_b32 s3, s3, 1
    s_lshl_b32 s3, s3, 13
    s_add_u32 s16, s16, s3
    s_add_u32 s17, s17, 1
    s_add_u32 m0, s60, 8192
    s_nop 0
    buffer_load_dwordx4 v56, s[8:11], s16 offen offset:0 sc1 nt lds
    buffer_load_dwordx4 v57, s[8:11], s16 offen offset:1024 sc1 nt lds
    s_add_u32 m0, s60, 10240
    s_nop 0
    buffer_load_dwordx4 v58, s[8:11], s16 offen offset:0 sc1 nt lds
    buffer_load_dwordx4 v59, s[8:11], s16 offen offset:1024 sc1 nt lds
    s_add_u32 m0, s60, 12288
    s_nop 0
    buffer_load_dwordx4 v60, s[8:11], s16 offen offset:0 sc1 nt lds
    buffer_load_dwordx4 v61, s[8:11], s16 offen offset:1024 sc1 nt lds
    s_add_u32 m0, s60, 14336
    s_nop 0
    buffer_load_dwordx4 v62, s[8:11], s16 offen offset:0 sc1 nt lds
    buffer_load_dwordx4 v63, s[8:11], s16 offen offset:1024 sc1 nt lds
    s_and_b32 s16, s17, 63
    s_lshl_b32 s16, s16, 15
    s_add_u32 s16, s16, s39
    s_xor_b32 s3, s17, s19
    s_and_b32 s3, s3, 1
    s_lshl_b32 s3, s3, 13
    s_add_u32 s16, s16, s3
    s_add_u32 s17, s17, 1
    s_add_u32 m0, s60, 16384
    s_nop 0
    buffer_load_dwordx4 v56, s[8:11], s16 offen offset:0 sc1 nt lds
    buffer_load_dwordx4 v57, s[8:11], s16 offen offset:1024 sc1 nt lds
    s_add_u32 m0, s60, 18432
    s_nop 0
    buffer_load_dwordx4 v58, s[8:11], s16 offen offset:0 sc1 nt lds
    buffer_load_dwordx4 v59, s[8:11], s16 offen offset:1024 sc1 nt lds
    s_add_u32 m0, s60, 20480
    s_nop 0
    buffer_load_dwordx4 v60, s[8:11], s16 offen offset:0 sc1 nt lds
    buffer_load_dwordx4 v61, s[8:11], s16 offen offset:1024 sc1 nt lds
    s_mov_b32 s12, s52
    s_mov_b32 s13, s53
    s_mov_b32 s40, s62
    s_mov_b32 s41, s63
    s_mov_b32 s42, 0x40000000
    s_mov_b32 s44, s58
    s_mov_b32 s45, s59
    s_mov_b32 s46, 256
    s_mov_b32 s4, s56
    s_mov_b32 s5, s57
    s_mov_b32 s6, 8192
    s_mov_b32 s7, 0x20000
    v_lshlrev_b32 v24, 10, v24
    v_bfe_u32 v25, v6, 3, 1
    v_lshl_add_u32 v24, v25, 9, v24
    v_add_u32 v24, s60, v24
    v_and_b32 v25, 15, v6
    v_xor_b32 v25, v25, v27
    v_xor_b32 v26, 0, v25
    v_lshl_add_u32 v52, v26, 4, v24
    v_xor_b32 v26, 4, v25
    v_lshl_add_u32 v53, v26, 4, v24
    v_xor_b32 v26, 8, v25
    v_lshl_add_u32 v54, v26, 4, v24
    v_xor_b32 v26, 12, v25
    v_lshl_add_u32 v55, v26, 4, v24
    s_mul_i32 s3, s19, 32768
    s_add_u32 s3, s3, 65536
    v_lshl_add_u32 v1, v6, 3, s3
    v_mov_b32 v7, v1
    v_lshlrev_b32 v2, 4, v6
    v_add_u32 v3, 4096, v2
    s_mov_b32 s20, 0x100001
    s_mov_b32 s21, 0x10000100
    s_mov_b32 s22, 0x200002
    s_mov_b32 s23, 0x20000200
    s_mov_b32 s24, 0x400004
    s_mov_b32 s25, 0x40000400
    s_mov_b32 s26, 0x800008
    s_mov_b32 s27, 0x80000800
    s_mov_b32 s28, 0x00ff00ff
    s_mov_b32 s29, 0x00ff00ff
    s_mov_b32 s30, 0xff00ff00
    s_mov_b32 s31, 0xff00ff00
    s_mov_b32 s32, 0x05040100
    s_mov_b32 s33, 0x07060302
    s_mov_b32 s34, 0x3fb8aa3b
    s_mov_b32 s35, 0x3eb504f3
    s_mov_b32 s36, 0x358637bd
    s_mov_b32 s37, 0x3e800000
    v_mov_b32 v4, 0x3d000000
    v_mov_b32 v8, 0x3f803f80
    v_mov_b32 v9, 0x3f803f80
    v_mov_b32 v10, 0x3f803f80
    v_mov_b32 v11, 0x3f803f80
    v_mov_b32 v64, 0
    v_mov_b32 v65, 0
    v_mov_b32 v66, 0
    v_mov_b32 v67, 0
    v_mov_b32 v68, 0
    v_mov_b32 v69, 0
    v_mov_b32 v70, 0
    v_mov_b32 v71, 0
    v_mov_b32 v72, 0
    v_mov_b32 v73, 0
    v_mov_b32 v74, 0
    v_mov_b32 v75, 0
    v_mov_b32 v76, 0
    v_mov_b32 v77, 0
    v_mov_b32 v78, 0
    v_mov_b32 v79, 0
    v_mov_b32 v80, 0
    v_mov_b32 v81, 0
    v_mov_b32 v82, 0
    v_mov_b32 v83, 0
    v_mov_b32 v84, 0
    v_mov_b32 v85, 0
    v_mov_b32 v86, 0
    v_mov_b32 v87, 0
    v_mov_b32 v88, 0
    v_mov_b32 v89, 0
    v_mov_b32 v90, 0
    v_mov_b32 v91, 0
    v_mov_b32 v92, 0
    v_mov_b32 v93, 0
    v_mov_b32 v94, 0
    v_mov_b32 v95, 0
    v_mov_b32 v96, 0
    v_mov_b32 v97, 0
    v_mov_b32 v98, 0
    v_mov_b32 v99, 0
    s_cmp_lg_u32 s19, 0
    s_cbranch_scc1 L_noclear_standalone__linear_kernel_rfa__decode_kernel
    v_mov_b32 v44, -1
    v_mov_b32 v45, -1
    v_mov_b32 v46, -1
    v_mov_b32 v47, -1
    v_and_b32 v26, 16, v6
    s_lshl_b32 s3, s2, 10
    buffer_store_dwordx4 v[44:47], v2, s[40:43], s3 offen sc1
    s_lshl_b32 s3, s2, 5
    s_add_u32 s3, s3, 1048576
    s_mov_b64 exec, 0x10001
    buffer_store_dwordx4 v[44:47], v26, s[40:43], s3 offen sc1
    s_mov_b64 exec, -1
L_noclear_standalone__linear_kernel_rfa__decode_kernel:
    s_mov_b32 s18, 1
L_kloop1_standalone__linear_kernel_rfa__decode_kernel:
    s_waitcnt vmcnt(14)
    ds_read_b128 a[0:3], v52 offset:0
    ds_read_b128 a[4:7], v53 offset:0
    ds_read_b128 a[8:11], v54 offset:0
    ds_read_b128 a[12:15], v55 offset:0
    ds_read_b128 a[16:19], v52 offset:256
    ds_read_b128 a[20:23], v53 offset:256
    ds_read_b128 a[24:27], v54 offset:256
    ds_read_b128 a[28:31], v55 offset:256
    s_add_u32 m0, s60, 22528
    s_nop 0
    buffer_load_dwordx4 v62, s[8:11], s16 offen offset:0 sc1 nt lds
    buffer_load_dwordx4 v63, s[8:11], s16 offen offset:1024 sc1 nt lds
    s_waitcnt lgkmcnt(7)
    v_mfma_f32_16x16x32_bf16 v[12:15], a[0:3], a[32:35], 0
    v_mfma_f32_16x16x32_bf16 v[16:19], a[0:3], a[0:3], 0
    s_waitcnt lgkmcnt(6)
    v_mfma_f32_16x16x32_bf16 v[12:15], a[4:7], a[36:39], v[12:15]
    v_mfma_f32_16x16x32_bf16 v[16:19], a[4:7], a[4:7], v[16:19]
    s_waitcnt lgkmcnt(5)
    v_mfma_f32_16x16x32_bf16 v[12:15], a[8:11], a[40:43], v[12:15]
    v_mfma_f32_16x16x32_bf16 v[16:19], a[8:11], a[8:11], v[16:19]
    s_waitcnt lgkmcnt(4)
    v_mfma_f32_16x16x32_bf16 v[12:15], a[12:15], a[44:47], v[12:15]
    v_mfma_f32_16x16x32_bf16 v[16:19], a[12:15], a[12:15], v[16:19]
    s_waitcnt lgkmcnt(3)
    v_mfma_f32_16x16x32_bf16 v[12:15], a[16:19], a[48:51], v[12:15]
    s_waitcnt vmcnt(14)
    s_and_b32 s16, s17, 63
    s_lshl_b32 s16, s16, 15
    s_add_u32 s16, s16, s39
    s_xor_b32 s3, s17, s19
    s_and_b32 s3, s3, 1
    s_lshl_b32 s3, s3, 13
    s_add_u32 s16, s16, s3
    s_add_u32 s17, s17, 1
    s_add_u32 m0, s60, 24576
    s_nop 0
    buffer_load_dwordx4 v56, s[8:11], s16 offen offset:0 sc1 nt lds
    buffer_load_dwordx4 v57, s[8:11], s16 offen offset:1024 sc1 nt lds
    v_mfma_f32_16x16x32_bf16 v[16:19], a[16:19], a[16:19], v[16:19]
    s_waitcnt lgkmcnt(2)
    v_mfma_f32_16x16x32_bf16 v[12:15], a[20:23], a[52:55], v[12:15]
    v_mfma_f32_16x16x32_bf16 v[16:19], a[20:23], a[20:23], v[16:19]
    s_waitcnt lgkmcnt(1)
    v_mfma_f32_16x16x32_bf16 v[12:15], a[24:27], a[56:59], v[12:15]
    v_mfma_f32_16x16x32_bf16 v[16:19], a[24:27], a[24:27], v[16:19]
    s_waitcnt lgkmcnt(0)
    v_mfma_f32_16x16x32_bf16 v[12:15], a[28:31], a[60:63], v[12:15]
    v_mfma_f32_16x16x32_bf16 v[16:19], a[28:31], a[28:31], v[16:19]
    s_nop 7
    s_waitcnt vmcnt(14)
    s_add_u32 m0, s60, 26624
    s_nop 0
    buffer_load_dwordx4 v58, s[8:11], s16 offen offset:0 sc1 nt lds
    buffer_load_dwordx4 v59, s[8:11], s16 offen offset:1024 sc1 nt lds
    v_cndmask_b32 v5, 0, v16, s[20:21]
    v_cndmask_b32 v5, v5, v17, s[22:23]
    v_cndmask_b32 v5, v5, v18, s[24:25]
    v_cndmask_b32 v5, v5, v19, s[26:27]
    s_nop 1
    v_mfma_f32_16x16x4_f32 v[20:23], v5, v4, 0
    v_mul_f32 v12, s37, v12
    v_mul_f32 v13, s37, v13
    v_mul_f32 v14, s37, v14
    v_mul_f32 v15, s37, v15
    v_cvt_pk_bf16_f32 v24, v12, v13
    v_cvt_pk_bf16_f32 v25, v14, v15
    v_lshlrev_b32 v12, 16, v24
    v_and_b32 v13, 0xffff0000, v24
    v_lshlrev_b32 v14, 16, v25
    v_and_b32 v15, 0xffff0000, v25
    v_cvt_pk_bf16_f32 v24, v20, v21
    v_cvt_pk_bf16_f32 v25, v22, v23
    v_lshlrev_b32 v28, 16, v24
    v_and_b32 v29, 0xffff0000, v24
    v_lshlrev_b32 v30, 16, v25
    v_and_b32 v31, 0xffff0000, v25
    v_sub_f32 v12, v12, v28
    v_sub_f32 v13, v13, v29
    v_sub_f32 v14, v14, v30
    v_sub_f32 v15, v15, v31
    v_cvt_pk_bf16_f32 v24, v12, v13
    v_cvt_pk_bf16_f32 v25, v14, v15
    v_lshlrev_b32 v12, 16, v24
    v_and_b32 v13, 0xffff0000, v24
    v_lshlrev_b32 v14, 16, v25
    s_waitcnt vmcnt(14)
    s_add_u32 m0, s60, 28672
    s_nop 0
    buffer_load_dwordx4 v60, s[8:11], s16 offen offset:0 sc1 nt lds
    buffer_load_dwordx4 v61, s[8:11], s16 offen offset:1024 sc1 nt lds
    v_and_b32 v15, 0xffff0000, v25
    v_mul_f32 v12, s34, v12
    v_mul_f32 v13, s34, v13
    v_mul_f32 v14, s34, v14
    v_mul_f32 v15, s34, v15
    v_exp_f32 v12, v12
    v_exp_f32 v13, v13
    v_exp_f32 v14, v14
    v_exp_f32 v15, v15
    s_nop 0
    v_cvt_pk_bf16_f32 v24, v12, v13
    v_cvt_pk_bf16_f32 v25, v14, v15
    v_lshlrev_b32 v12, 16, v24
    v_and_b32 v13, 0xffff0000, v24
    v_lshlrev_b32 v14, 16, v25
    v_and_b32 v15, 0xffff0000, v25
    v_mul_f32 v12, s35, v12
    v_mul_f32 v13, s35, v13
    v_mul_f32 v14, s35, v14
    v_mul_f32 v15, s35, v15
    v_cvt_pk_bf16_f32 v24, v12, v13
    v_cvt_pk_bf16_f32 v25, v14, v15
    v_lshlrev_b32 v12, 16, v24
    v_and_b32 v13, 0xffff0000, v24
    v_lshlrev_b32 v14, 16, v25
    v_and_b32 v15, 0xffff0000, v25
    v_add_f32 v12, s36, v12
    v_add_f32 v13, s36, v13
    v_add_f32 v14, s36, v14
    v_add_f32 v15, s36, v15
    v_cvt_pk_bf16_f32 v24, v12, v13
    v_cvt_pk_bf16_f32 v25, v14, v15
    ds_write_b64 v1, v[24:25] offset:0
    s_waitcnt vmcnt(14)
    ds_read_b128 a[0:3], v52 offset:8192
    ds_read_b128 a[4:7], v53 offset:8192
    ds_read_b128 a[8:11], v54 offset:8192
    ds_read_b128 a[12:15], v55 offset:8192
    ds_read_b128 a[16:19], v52 offset:8448
    ds_read_b128 a[20:23], v53 offset:8448
    ds_read_b128 a[24:27], v54 offset:8448
    ds_read_b128 a[28:31], v55 offset:8448
    s_add_u32 m0, s60, 30720
    s_nop 0
    buffer_load_dwordx4 v62, s[8:11], s16 offen offset:0 sc1 nt lds
    buffer_load_dwordx4 v63, s[8:11], s16 offen offset:1024 sc1 nt lds
    s_waitcnt lgkmcnt(7)
    v_mfma_f32_16x16x32_bf16 v[12:15], a[0:3], a[32:35], 0
    v_mfma_f32_16x16x32_bf16 v[16:19], a[0:3], a[0:3], 0
    s_waitcnt lgkmcnt(6)
    v_mfma_f32_16x16x32_bf16 v[12:15], a[4:7], a[36:39], v[12:15]
    v_mfma_f32_16x16x32_bf16 v[16:19], a[4:7], a[4:7], v[16:19]
    s_waitcnt lgkmcnt(5)
    v_mfma_f32_16x16x32_bf16 v[12:15], a[8:11], a[40:43], v[12:15]
    v_mfma_f32_16x16x32_bf16 v[16:19], a[8:11], a[8:11], v[16:19]
    s_waitcnt lgkmcnt(4)
    v_mfma_f32_16x16x32_bf16 v[12:15], a[12:15], a[44:47], v[12:15]
    v_mfma_f32_16x16x32_bf16 v[16:19], a[12:15], a[12:15], v[16:19]
    s_waitcnt lgkmcnt(3)
    v_mfma_f32_16x16x32_bf16 v[12:15], a[16:19], a[48:51], v[12:15]
    s_waitcnt vmcnt(14)
    s_and_b32 s16, s17, 63
    s_lshl_b32 s16, s16, 15
    s_add_u32 s16, s16, s39
    s_xor_b32 s3, s17, s19
    s_and_b32 s3, s3, 1
    s_lshl_b32 s3, s3, 13
    s_add_u32 s16, s16, s3
    s_add_u32 s17, s17, 1
    s_add_u32 m0, s60, 0
    s_nop 0
    buffer_load_dwordx4 v56, s[8:11], s16 offen offset:0 sc1 nt lds
    buffer_load_dwordx4 v57, s[8:11], s16 offen offset:1024 sc1 nt lds
    v_mfma_f32_16x16x32_bf16 v[16:19], a[16:19], a[16:19], v[16:19]
    s_waitcnt lgkmcnt(2)
    v_mfma_f32_16x16x32_bf16 v[12:15], a[20:23], a[52:55], v[12:15]
    v_mfma_f32_16x16x32_bf16 v[16:19], a[20:23], a[20:23], v[16:19]
    s_waitcnt lgkmcnt(1)
    v_mfma_f32_16x16x32_bf16 v[12:15], a[24:27], a[56:59], v[12:15]
    v_mfma_f32_16x16x32_bf16 v[16:19], a[24:27], a[24:27], v[16:19]
    s_waitcnt lgkmcnt(0)
    v_mfma_f32_16x16x32_bf16 v[12:15], a[28:31], a[60:63], v[12:15]
    v_mfma_f32_16x16x32_bf16 v[16:19], a[28:31], a[28:31], v[16:19]
    s_nop 7
    s_waitcnt vmcnt(14)
    s_add_u32 m0, s60, 2048
    s_nop 0
    buffer_load_dwordx4 v58, s[8:11], s16 offen offset:0 sc1 nt lds
    buffer_load_dwordx4 v59, s[8:11], s16 offen offset:1024 sc1 nt lds
    v_cndmask_b32 v5, 0, v16, s[20:21]
    v_cndmask_b32 v5, v5, v17, s[22:23]
    v_cndmask_b32 v5, v5, v18, s[24:25]
    v_cndmask_b32 v5, v5, v19, s[26:27]
    s_nop 1
    v_mfma_f32_16x16x4_f32 v[20:23], v5, v4, 0
    v_mul_f32 v12, s37, v12
    v_mul_f32 v13, s37, v13
    v_mul_f32 v14, s37, v14
    v_mul_f32 v15, s37, v15
    v_cvt_pk_bf16_f32 v24, v12, v13
    v_cvt_pk_bf16_f32 v25, v14, v15
    v_lshlrev_b32 v12, 16, v24
    v_and_b32 v13, 0xffff0000, v24
    v_lshlrev_b32 v14, 16, v25
    v_and_b32 v15, 0xffff0000, v25
    v_cvt_pk_bf16_f32 v24, v20, v21
    v_cvt_pk_bf16_f32 v25, v22, v23
    v_lshlrev_b32 v28, 16, v24
    v_and_b32 v29, 0xffff0000, v24
    v_lshlrev_b32 v30, 16, v25
    v_and_b32 v31, 0xffff0000, v25
    v_sub_f32 v12, v12, v28
    v_sub_f32 v13, v13, v29
    v_sub_f32 v14, v14, v30
    v_sub_f32 v15, v15, v31
    v_cvt_pk_bf16_f32 v24, v12, v13
    v_cvt_pk_bf16_f32 v25, v14, v15
    v_lshlrev_b32 v12, 16, v24
    v_and_b32 v13, 0xffff0000, v24
    v_lshlrev_b32 v14, 16, v25
    s_waitcnt vmcnt(14)
    s_add_u32 m0, s60, 4096
    s_nop 0
    buffer_load_dwordx4 v60, s[8:11], s16 offen offset:0 sc1 nt lds
    buffer_load_dwordx4 v61, s[8:11], s16 offen offset:1024 sc1 nt lds
    v_and_b32 v15, 0xffff0000, v25
    v_mul_f32 v12, s34, v12
    v_mul_f32 v13, s34, v13
    v_mul_f32 v14, s34, v14
    v_mul_f32 v15, s34, v15
    v_exp_f32 v12, v12
    v_exp_f32 v13, v13
    v_exp_f32 v14, v14
    v_exp_f32 v15, v15
    s_nop 0
    v_cvt_pk_bf16_f32 v24, v12, v13
    v_cvt_pk_bf16_f32 v25, v14, v15
    v_lshlrev_b32 v12, 16, v24
    v_and_b32 v13, 0xffff0000, v24
    v_lshlrev_b32 v14, 16, v25
    v_and_b32 v15, 0xffff0000, v25
    v_mul_f32 v12, s35, v12
    v_mul_f32 v13, s35, v13
    v_mul_f32 v14, s35, v14
    v_mul_f32 v15, s35, v15
    v_cvt_pk_bf16_f32 v24, v12, v13
    v_cvt_pk_bf16_f32 v25, v14, v15
    v_lshlrev_b32 v12, 16, v24
    v_and_b32 v13, 0xffff0000, v24
    v_lshlrev_b32 v14, 16, v25
    v_and_b32 v15, 0xffff0000, v25
    v_add_f32 v12, s36, v12
    v_add_f32 v13, s36, v13
    v_add_f32 v14, s36, v14
    v_add_f32 v15, s36, v15
    v_cvt_pk_bf16_f32 v24, v12, v13
    v_cvt_pk_bf16_f32 v25, v14, v15
    ds_write_b64 v1, v[24:25] offset:512
    s_waitcnt vmcnt(14)
    ds_read_b128 a[0:3], v52 offset:16384
    ds_read_b128 a[4:7], v53 offset:16384
    ds_read_b128 a[8:11], v54 offset:16384
    ds_read_b128 a[12:15], v55 offset:16384
    ds_read_b128 a[16:19], v52 offset:16640
    ds_read_b128 a[20:23], v53 offset:16640
    ds_read_b128 a[24:27], v54 offset:16640
    ds_read_b128 a[28:31], v55 offset:16640
    s_add_u32 m0, s60, 6144
    s_nop 0
    buffer_load_dwordx4 v62, s[8:11], s16 offen offset:0 sc1 nt lds
    buffer_load_dwordx4 v63, s[8:11], s16 offen offset:1024 sc1 nt lds
    s_waitcnt lgkmcnt(7)
    v_mfma_f32_16x16x32_bf16 v[12:15], a[0:3], a[32:35], 0
    v_mfma_f32_16x16x32_bf16 v[16:19], a[0:3], a[0:3], 0
    s_waitcnt lgkmcnt(6)
    v_mfma_f32_16x16x32_bf16 v[12:15], a[4:7], a[36:39], v[12:15]
    v_mfma_f32_16x16x32_bf16 v[16:19], a[4:7], a[4:7], v[16:19]
    s_waitcnt lgkmcnt(5)
    v_mfma_f32_16x16x32_bf16 v[12:15], a[8:11], a[40:43], v[12:15]
    v_mfma_f32_16x16x32_bf16 v[16:19], a[8:11], a[8:11], v[16:19]
    s_waitcnt lgkmcnt(4)
    v_mfma_f32_16x16x32_bf16 v[12:15], a[12:15], a[44:47], v[12:15]
    v_mfma_f32_16x16x32_bf16 v[16:19], a[12:15], a[12:15], v[16:19]
    s_waitcnt lgkmcnt(3)
    v_mfma_f32_16x16x32_bf16 v[12:15], a[16:19], a[48:51], v[12:15]
    s_waitcnt vmcnt(14)
    s_and_b32 s16, s17, 63
    s_lshl_b32 s16, s16, 15
    s_add_u32 s16, s16, s39
    s_xor_b32 s3, s17, s19
    s_and_b32 s3, s3, 1
    s_lshl_b32 s3, s3, 13
    s_add_u32 s16, s16, s3
    s_add_u32 s17, s17, 1
    s_add_u32 m0, s60, 8192
    s_nop 0
    buffer_load_dwordx4 v56, s[8:11], s16 offen offset:0 sc1 nt lds
    buffer_load_dwordx4 v57, s[8:11], s16 offen offset:1024 sc1 nt lds
    v_mfma_f32_16x16x32_bf16 v[16:19], a[16:19], a[16:19], v[16:19]
    s_waitcnt lgkmcnt(2)
    v_mfma_f32_16x16x32_bf16 v[12:15], a[20:23], a[52:55], v[12:15]
    v_mfma_f32_16x16x32_bf16 v[16:19], a[20:23], a[20:23], v[16:19]
    s_waitcnt lgkmcnt(1)
    v_mfma_f32_16x16x32_bf16 v[12:15], a[24:27], a[56:59], v[12:15]
    v_mfma_f32_16x16x32_bf16 v[16:19], a[24:27], a[24:27], v[16:19]
    s_waitcnt lgkmcnt(0)
    v_mfma_f32_16x16x32_bf16 v[12:15], a[28:31], a[60:63], v[12:15]
    v_mfma_f32_16x16x32_bf16 v[16:19], a[28:31], a[28:31], v[16:19]
    s_nop 7
    s_waitcnt vmcnt(14)
    s_add_u32 m0, s60, 10240
    s_nop 0
    buffer_load_dwordx4 v58, s[8:11], s16 offen offset:0 sc1 nt lds
    buffer_load_dwordx4 v59, s[8:11], s16 offen offset:1024 sc1 nt lds
    v_cndmask_b32 v5, 0, v16, s[20:21]
    v_cndmask_b32 v5, v5, v17, s[22:23]
    v_cndmask_b32 v5, v5, v18, s[24:25]
    v_cndmask_b32 v5, v5, v19, s[26:27]
    s_nop 1
    v_mfma_f32_16x16x4_f32 v[20:23], v5, v4, 0
    v_mul_f32 v12, s37, v12
    v_mul_f32 v13, s37, v13
    v_mul_f32 v14, s37, v14
    v_mul_f32 v15, s37, v15
    v_cvt_pk_bf16_f32 v24, v12, v13
    v_cvt_pk_bf16_f32 v25, v14, v15
    v_lshlrev_b32 v12, 16, v24
    v_and_b32 v13, 0xffff0000, v24
    v_lshlrev_b32 v14, 16, v25
    v_and_b32 v15, 0xffff0000, v25
    v_cvt_pk_bf16_f32 v24, v20, v21
    v_cvt_pk_bf16_f32 v25, v22, v23
    v_lshlrev_b32 v28, 16, v24
    v_and_b32 v29, 0xffff0000, v24
    v_lshlrev_b32 v30, 16, v25
    v_and_b32 v31, 0xffff0000, v25
    v_sub_f32 v12, v12, v28
    v_sub_f32 v13, v13, v29
    v_sub_f32 v14, v14, v30
    v_sub_f32 v15, v15, v31
    v_cvt_pk_bf16_f32 v24, v12, v13
    v_cvt_pk_bf16_f32 v25, v14, v15
    v_lshlrev_b32 v12, 16, v24
    v_and_b32 v13, 0xffff0000, v24
    v_lshlrev_b32 v14, 16, v25
    s_waitcnt vmcnt(14)
    s_add_u32 m0, s60, 12288
    s_nop 0
    buffer_load_dwordx4 v60, s[8:11], s16 offen offset:0 sc1 nt lds
    buffer_load_dwordx4 v61, s[8:11], s16 offen offset:1024 sc1 nt lds
    v_and_b32 v15, 0xffff0000, v25
    v_mul_f32 v12, s34, v12
    v_mul_f32 v13, s34, v13
    v_mul_f32 v14, s34, v14
    v_mul_f32 v15, s34, v15
    v_exp_f32 v12, v12
    v_exp_f32 v13, v13
    v_exp_f32 v14, v14
    v_exp_f32 v15, v15
    s_nop 0
    v_cvt_pk_bf16_f32 v24, v12, v13
    v_cvt_pk_bf16_f32 v25, v14, v15
    v_lshlrev_b32 v12, 16, v24
    v_and_b32 v13, 0xffff0000, v24
    v_lshlrev_b32 v14, 16, v25
    v_and_b32 v15, 0xffff0000, v25
    v_mul_f32 v12, s35, v12
    v_mul_f32 v13, s35, v13
    v_mul_f32 v14, s35, v14
    v_mul_f32 v15, s35, v15
    v_cvt_pk_bf16_f32 v24, v12, v13
    v_cvt_pk_bf16_f32 v25, v14, v15
    v_lshlrev_b32 v12, 16, v24
    v_and_b32 v13, 0xffff0000, v24
    v_lshlrev_b32 v14, 16, v25
    v_and_b32 v15, 0xffff0000, v25
    v_add_f32 v12, s36, v12
    v_add_f32 v13, s36, v13
    v_add_f32 v14, s36, v14
    v_add_f32 v15, s36, v15
    v_cvt_pk_bf16_f32 v24, v12, v13
    v_cvt_pk_bf16_f32 v25, v14, v15
    ds_write_b64 v1, v[24:25] offset:1024
    s_waitcnt vmcnt(14)
    ds_read_b128 a[0:3], v52 offset:24576
    ds_read_b128 a[4:7], v53 offset:24576
    ds_read_b128 a[8:11], v54 offset:24576
    ds_read_b128 a[12:15], v55 offset:24576
    ds_read_b128 a[16:19], v52 offset:24832
    ds_read_b128 a[20:23], v53 offset:24832
    ds_read_b128 a[24:27], v54 offset:24832
    ds_read_b128 a[28:31], v55 offset:24832
    s_add_u32 m0, s60, 14336
    s_nop 0
    buffer_load_dwordx4 v62, s[8:11], s16 offen offset:0 sc1 nt lds
    buffer_load_dwordx4 v63, s[8:11], s16 offen offset:1024 sc1 nt lds
    s_waitcnt lgkmcnt(7)
    v_mfma_f32_16x16x32_bf16 v[12:15], a[0:3], a[32:35], 0
    v_mfma_f32_16x16x32_bf16 v[16:19], a[0:3], a[0:3], 0
    s_waitcnt lgkmcnt(6)
    v_mfma_f32_16x16x32_bf16 v[12:15], a[4:7], a[36:39], v[12:15]
    v_mfma_f32_16x16x32_bf16 v[16:19], a[4:7], a[4:7], v[16:19]
    s_waitcnt lgkmcnt(5)
    v_mfma_f32_16x16x32_bf16 v[12:15], a[8:11], a[40:43], v[12:15]
    v_mfma_f32_16x16x32_bf16 v[16:19], a[8:11], a[8:11], v[16:19]
    s_waitcnt lgkmcnt(4)
    v_mfma_f32_16x16x32_bf16 v[12:15], a[12:15], a[44:47], v[12:15]
    v_mfma_f32_16x16x32_bf16 v[16:19], a[12:15], a[12:15], v[16:19]
    s_waitcnt lgkmcnt(3)
    v_mfma_f32_16x16x32_bf16 v[12:15], a[16:19], a[48:51], v[12:15]
    s_waitcnt vmcnt(14)
    s_and_b32 s16, s17, 63
    s_lshl_b32 s16, s16, 15
    s_add_u32 s16, s16, s39
    s_xor_b32 s3, s17, s19
    s_and_b32 s3, s3, 1
    s_lshl_b32 s3, s3, 13
    s_add_u32 s16, s16, s3
    s_add_u32 s17, s17, 1
    s_add_u32 m0, s60, 16384
    s_nop 0
    buffer_load_dwordx4 v56, s[8:11], s16 offen offset:0 sc1 nt lds
    buffer_load_dwordx4 v57, s[8:11], s16 offen offset:1024 sc1 nt lds
    v_mfma_f32_16x16x32_bf16 v[16:19], a[16:19], a[16:19], v[16:19]
    s_waitcnt lgkmcnt(2)
    v_mfma_f32_16x16x32_bf16 v[12:15], a[20:23], a[52:55], v[12:15]
    v_mfma_f32_16x16x32_bf16 v[16:19], a[20:23], a[20:23], v[16:19]
    s_waitcnt lgkmcnt(1)
    v_mfma_f32_16x16x32_bf16 v[12:15], a[24:27], a[56:59], v[12:15]
    v_mfma_f32_16x16x32_bf16 v[16:19], a[24:27], a[24:27], v[16:19]
    s_waitcnt lgkmcnt(0)
    v_mfma_f32_16x16x32_bf16 v[12:15], a[28:31], a[60:63], v[12:15]
    v_mfma_f32_16x16x32_bf16 v[16:19], a[28:31], a[28:31], v[16:19]
    s_nop 7
    s_waitcnt vmcnt(14)
    s_add_u32 m0, s60, 18432
    s_nop 0
    buffer_load_dwordx4 v58, s[8:11], s16 offen offset:0 sc1 nt lds
    buffer_load_dwordx4 v59, s[8:11], s16 offen offset:1024 sc1 nt lds
    v_cndmask_b32 v5, 0, v16, s[20:21]
    v_cndmask_b32 v5, v5, v17, s[22:23]
    v_cndmask_b32 v5, v5, v18, s[24:25]
    v_cndmask_b32 v5, v5, v19, s[26:27]
    s_nop 1
    v_mfma_f32_16x16x4_f32 v[20:23], v5, v4, 0
    v_mul_f32 v12, s37, v12
    v_mul_f32 v13, s37, v13
    v_mul_f32 v14, s37, v14
    v_mul_f32 v15, s37, v15
    v_cvt_pk_bf16_f32 v24, v12, v13
    v_cvt_pk_bf16_f32 v25, v14, v15
    v_lshlrev_b32 v12, 16, v24
    v_and_b32 v13, 0xffff0000, v24
    v_lshlrev_b32 v14, 16, v25
    v_and_b32 v15, 0xffff0000, v25
    v_cvt_pk_bf16_f32 v24, v20, v21
    v_cvt_pk_bf16_f32 v25, v22, v23
    v_lshlrev_b32 v28, 16, v24
    v_and_b32 v29, 0xffff0000, v24
    v_lshlrev_b32 v30, 16, v25
    v_and_b32 v31, 0xffff0000, v25
    v_sub_f32 v12, v12, v28
    v_sub_f32 v13, v13, v29
    v_sub_f32 v14, v14, v30
    v_sub_f32 v15, v15, v31
    v_cvt_pk_bf16_f32 v24, v12, v13
    v_cvt_pk_bf16_f32 v25, v14, v15
    v_lshlrev_b32 v12, 16, v24
    v_and_b32 v13, 0xffff0000, v24
    v_lshlrev_b32 v14, 16, v25
    s_waitcnt vmcnt(14)
    s_add_u32 m0, s60, 20480
    s_nop 0
    buffer_load_dwordx4 v60, s[8:11], s16 offen offset:0 sc1 nt lds
    buffer_load_dwordx4 v61, s[8:11], s16 offen offset:1024 sc1 nt lds
    v_and_b32 v15, 0xffff0000, v25
    v_mul_f32 v12, s34, v12
    v_mul_f32 v13, s34, v13
    v_mul_f32 v14, s34, v14
    v_mul_f32 v15, s34, v15
    v_exp_f32 v12, v12
    v_exp_f32 v13, v13
    v_exp_f32 v14, v14
    v_exp_f32 v15, v15
    s_nop 0
    v_cvt_pk_bf16_f32 v24, v12, v13
    v_cvt_pk_bf16_f32 v25, v14, v15
    v_lshlrev_b32 v12, 16, v24
    v_and_b32 v13, 0xffff0000, v24
    v_lshlrev_b32 v14, 16, v25
    v_and_b32 v15, 0xffff0000, v25
    v_mul_f32 v12, s35, v12
    v_mul_f32 v13, s35, v13
    v_mul_f32 v14, s35, v14
    v_mul_f32 v15, s35, v15
    v_cvt_pk_bf16_f32 v24, v12, v13
    v_cvt_pk_bf16_f32 v25, v14, v15
    v_lshlrev_b32 v12, 16, v24
    v_and_b32 v13, 0xffff0000, v24
    v_lshlrev_b32 v14, 16, v25
    v_and_b32 v15, 0xffff0000, v25
    v_add_f32 v12, s36, v12
    v_add_f32 v13, s36, v13
    v_add_f32 v14, s36, v14
    v_add_f32 v15, s36, v15
    v_cvt_pk_bf16_f32 v24, v12, v13
    v_cvt_pk_bf16_f32 v25, v14, v15
    ds_write_b64 v1, v[24:25] offset:1536
    v_add_u32 v1, 2048, v1
    s_sub_u32 s18, s18, 1
    s_cmp_lg_u32 s18, 0
    s_cbranch_scc1 L_kloop1_standalone__linear_kernel_rfa__decode_kernel
    s_mov_b32 s18, 14
L_kloop_standalone__linear_kernel_rfa__decode_kernel:
    s_waitcnt vmcnt(9)
    ds_read_b128 a[0:3], v52 offset:0
    ds_read_b128 a[4:7], v53 offset:0
    ds_read_b128 a[8:11], v54 offset:0
    ds_read_b128 a[12:15], v55 offset:0
    ds_read_b128 a[16:19], v52 offset:256
    ds_read_b128 a[20:23], v53 offset:256
    ds_read_b128 a[24:27], v54 offset:256
    ds_read_b128 a[28:31], v55 offset:256
    s_add_u32 m0, s60, 22528
    s_nop 0
    buffer_load_dwordx4 v62, s[8:11], s16 offen offset:0 sc1 nt lds
    buffer_load_dwordx4 v63, s[8:11], s16 offen offset:1024 sc1 nt lds
    s_waitcnt lgkmcnt(7)
    v_mfma_f32_16x16x32_bf16 v[12:15], a[0:3], a[32:35], 0
    v_mfma_f32_16x16x32_bf16 v[16:19], a[0:3], a[0:3], 0
    s_waitcnt lgkmcnt(6)
    v_mfma_f32_16x16x32_bf16 v[12:15], a[4:7], a[36:39], v[12:15]
    v_mfma_f32_16x16x32_bf16 v[16:19], a[4:7], a[4:7], v[16:19]
    s_waitcnt lgkmcnt(5)
    v_mfma_f32_16x16x32_bf16 v[12:15], a[8:11], a[40:43], v[12:15]
    v_mfma_f32_16x16x32_bf16 v[16:19], a[8:11], a[8:11], v[16:19]
    s_waitcnt lgkmcnt(4)
    v_mfma_f32_16x16x32_bf16 v[12:15], a[12:15], a[44:47], v[12:15]
    v_mfma_f32_16x16x32_bf16 v[16:19], a[12:15], a[12:15], v[16:19]
    s_waitcnt lgkmcnt(3)
    v_mfma_f32_16x16x32_bf16 v[12:15], a[16:19], a[48:51], v[12:15]
    s_waitcnt vmcnt(9)
    s_and_b32 s16, s17, 63
    s_lshl_b32 s16, s16, 15
    s_add_u32 s16, s16, s39
    s_xor_b32 s3, s17, s19
    s_and_b32 s3, s3, 1
    s_lshl_b32 s3, s3, 13
    s_add_u32 s16, s16, s3
    s_add_u32 s17, s17, 1
    s_add_u32 m0, s60, 24576
    s_nop 0
    buffer_load_dwordx4 v56, s[8:11], s16 offen offset:0 sc1 nt lds
    buffer_load_dwordx4 v57, s[8:11], s16 offen offset:1024 sc1 nt lds
    v_mfma_f32_16x16x32_bf16 v[16:19], a[16:19], a[16:19], v[16:19]
    s_waitcnt lgkmcnt(2)
    v_mfma_f32_16x16x32_bf16 v[12:15], a[20:23], a[52:55], v[12:15]
    v_mfma_f32_16x16x32_bf16 v[16:19], a[20:23], a[20:23], v[16:19]
    s_waitcnt lgkmcnt(1)
    v_mfma_f32_16x16x32_bf16 v[12:15], a[24:27], a[56:59], v[12:15]
    v_mfma_f32_16x16x32_bf16 v[16:19], a[24:27], a[24:27], v[16:19]
    s_waitcnt lgkmcnt(0)
    v_mfma_f32_16x16x32_bf16 v[12:15], a[28:31], a[60:63], v[12:15]
    v_mfma_f32_16x16x32_bf16 v[16:19], a[28:31], a[28:31], v[16:19]
    s_nop 7
    s_waitcnt vmcnt(9)
    s_add_u32 m0, s60, 26624
    s_nop 0
    buffer_load_dwordx4 v58, s[8:11], s16 offen offset:0 sc1 nt lds
    buffer_load_dwordx4 v59, s[8:11], s16 offen offset:1024 sc1 nt lds
    v_cndmask_b32 v5, 0, v16, s[20:21]
    v_cndmask_b32 v5, v5, v17, s[22:23]
    v_cndmask_b32 v5, v5, v18, s[24:25]
    v_cndmask_b32 v5, v5, v19, s[26:27]
    s_nop 1
    v_mfma_f32_16x16x4_f32 v[20:23], v5, v4, 0
    v_mul_f32 v12, s37, v12
    v_mul_f32 v13, s37, v13
    v_mul_f32 v14, s37, v14
    v_mul_f32 v15, s37, v15
    v_cvt_pk_bf16_f32 v24, v12, v13
    v_cvt_pk_bf16_f32 v25, v14, v15
    v_lshlrev_b32 v12, 16, v24
    v_and_b32 v13, 0xffff0000, v24
    v_lshlrev_b32 v14, 16, v25
    v_and_b32 v15, 0xffff0000, v25
    v_cvt_pk_bf16_f32 v24, v20, v21
    v_cvt_pk_bf16_f32 v25, v22, v23
    v_lshlrev_b32 v28, 16, v24
    v_and_b32 v29, 0xffff0000, v24
    v_lshlrev_b32 v30, 16, v25
    v_and_b32 v31, 0xffff0000, v25
    v_sub_f32 v12, v12, v28
    v_sub_f32 v13, v13, v29
    v_sub_f32 v14, v14, v30
    v_sub_f32 v15, v15, v31
    v_cvt_pk_bf16_f32 v24, v12, v13
    v_cvt_pk_bf16_f32 v25, v14, v15
    v_lshlrev_b32 v12, 16, v24
    v_and_b32 v13, 0xffff0000, v24
    v_lshlrev_b32 v14, 16, v25
    s_waitcnt vmcnt(9)
    s_add_u32 m0, s60, 28672
    s_nop 0
    buffer_load_dwordx4 v60, s[8:11], s16 offen offset:0 sc1 nt lds
    buffer_load_dwordx4 v61, s[8:11], s16 offen offset:1024 sc1 nt lds
    v_and_b32 v15, 0xffff0000, v25
    v_mul_f32 v12, s34, v12
    v_mul_f32 v13, s34, v13
    v_mul_f32 v14, s34, v14
    v_mul_f32 v15, s34, v15
    v_exp_f32 v12, v12
    v_exp_f32 v13, v13
    v_exp_f32 v14, v14
    v_exp_f32 v15, v15
    s_nop 0
    v_cvt_pk_bf16_f32 v24, v12, v13
    v_cvt_pk_bf16_f32 v25, v14, v15
    v_lshlrev_b32 v12, 16, v24
    v_and_b32 v13, 0xffff0000, v24
    v_lshlrev_b32 v14, 16, v25
    v_and_b32 v15, 0xffff0000, v25
    v_mul_f32 v12, s35, v12
    v_mul_f32 v13, s35, v13
    v_mul_f32 v14, s35, v14
    v_mul_f32 v15, s35, v15
    v_cvt_pk_bf16_f32 v24, v12, v13
    v_cvt_pk_bf16_f32 v25, v14, v15
    v_lshlrev_b32 v12, 16, v24
    v_and_b32 v13, 0xffff0000, v24
    v_lshlrev_b32 v14, 16, v25
    v_and_b32 v15, 0xffff0000, v25
    v_add_f32 v12, s36, v12
    v_add_f32 v13, s36, v13
    v_add_f32 v14, s36, v14
    v_add_f32 v15, s36, v15
    v_cvt_pk_bf16_f32 v24, v12, v13
    v_cvt_pk_bf16_f32 v25, v14, v15
    ds_write_b64 v1, v[24:25] offset:0
    s_waitcnt vmcnt(9)
    ds_read_b128 a[0:3], v52 offset:8192
    ds_read_b128 a[4:7], v53 offset:8192
    ds_read_b128 a[8:11], v54 offset:8192
    ds_read_b128 a[12:15], v55 offset:8192
    ds_read_b128 a[16:19], v52 offset:8448
    ds_read_b128 a[20:23], v53 offset:8448
    ds_read_b128 a[24:27], v54 offset:8448
    ds_read_b128 a[28:31], v55 offset:8448
    s_add_u32 m0, s60, 30720
    s_nop 0
    buffer_load_dwordx4 v62, s[8:11], s16 offen offset:0 sc1 nt lds
    buffer_load_dwordx4 v63, s[8:11], s16 offen offset:1024 sc1 nt lds
    s_waitcnt lgkmcnt(7)
    v_mfma_f32_16x16x32_bf16 v[12:15], a[0:3], a[32:35], 0
    v_mfma_f32_16x16x32_bf16 v[16:19], a[0:3], a[0:3], 0
    s_waitcnt lgkmcnt(6)
    v_mfma_f32_16x16x32_bf16 v[12:15], a[4:7], a[36:39], v[12:15]
    v_mfma_f32_16x16x32_bf16 v[16:19], a[4:7], a[4:7], v[16:19]
    s_waitcnt lgkmcnt(5)
    v_mfma_f32_16x16x32_bf16 v[12:15], a[8:11], a[40:43], v[12:15]
    v_mfma_f32_16x16x32_bf16 v[16:19], a[8:11], a[8:11], v[16:19]
    s_waitcnt lgkmcnt(4)
    v_mfma_f32_16x16x32_bf16 v[12:15], a[12:15], a[44:47], v[12:15]
    v_mfma_f32_16x16x32_bf16 v[16:19], a[12:15], a[12:15], v[16:19]
    s_waitcnt lgkmcnt(3)
    v_mfma_f32_16x16x32_bf16 v[12:15], a[16:19], a[48:51], v[12:15]
    s_waitcnt vmcnt(9)
    s_and_b32 s16, s17, 63
    s_lshl_b32 s16, s16, 15
    s_add_u32 s16, s16, s39
    s_xor_b32 s3, s17, s19
    s_and_b32 s3, s3, 1
    s_lshl_b32 s3, s3, 13
    s_add_u32 s16, s16, s3
    s_add_u32 s17, s17, 1
    s_add_u32 m0, s60, 0
    s_nop 0
    buffer_load_dwordx4 v56, s[8:11], s16 offen offset:0 sc1 nt lds
    buffer_load_dwordx4 v57, s[8:11], s16 offen offset:1024 sc1 nt lds
    v_mfma_f32_16x16x32_bf16 v[16:19], a[16:19], a[16:19], v[16:19]
    s_waitcnt lgkmcnt(2)
    v_mfma_f32_16x16x32_bf16 v[12:15], a[20:23], a[52:55], v[12:15]
    v_mfma_f32_16x16x32_bf16 v[16:19], a[20:23], a[20:23], v[16:19]
    s_waitcnt lgkmcnt(1)
    v_mfma_f32_16x16x32_bf16 v[12:15], a[24:27], a[56:59], v[12:15]
    v_mfma_f32_16x16x32_bf16 v[16:19], a[24:27], a[24:27], v[16:19]
    s_waitcnt lgkmcnt(0)
    v_mfma_f32_16x16x32_bf16 v[12:15], a[28:31], a[60:63], v[12:15]
    v_mfma_f32_16x16x32_bf16 v[16:19], a[28:31], a[28:31], v[16:19]
    s_nop 7
    s_waitcnt vmcnt(9)
    s_add_u32 m0, s60, 2048
    s_nop 0
    buffer_load_dwordx4 v58, s[8:11], s16 offen offset:0 sc1 nt lds
    buffer_load_dwordx4 v59, s[8:11], s16 offen offset:1024 sc1 nt lds
    v_cndmask_b32 v5, 0, v16, s[20:21]
    v_cndmask_b32 v5, v5, v17, s[22:23]
    v_cndmask_b32 v5, v5, v18, s[24:25]
    v_cndmask_b32 v5, v5, v19, s[26:27]
    s_nop 1
    v_mfma_f32_16x16x4_f32 v[20:23], v5, v4, 0
    v_mul_f32 v12, s37, v12
    v_mul_f32 v13, s37, v13
    v_mul_f32 v14, s37, v14
    v_mul_f32 v15, s37, v15
    v_cvt_pk_bf16_f32 v24, v12, v13
    v_cvt_pk_bf16_f32 v25, v14, v15
    v_lshlrev_b32 v12, 16, v24
    v_and_b32 v13, 0xffff0000, v24
    v_lshlrev_b32 v14, 16, v25
    v_and_b32 v15, 0xffff0000, v25
    v_cvt_pk_bf16_f32 v24, v20, v21
    v_cvt_pk_bf16_f32 v25, v22, v23
    v_lshlrev_b32 v28, 16, v24
    v_and_b32 v29, 0xffff0000, v24
    v_lshlrev_b32 v30, 16, v25
    v_and_b32 v31, 0xffff0000, v25
    v_sub_f32 v12, v12, v28
    v_sub_f32 v13, v13, v29
    v_sub_f32 v14, v14, v30
    v_sub_f32 v15, v15, v31
    v_cvt_pk_bf16_f32 v24, v12, v13
    v_cvt_pk_bf16_f32 v25, v14, v15
    v_lshlrev_b32 v12, 16, v24
    v_and_b32 v13, 0xffff0000, v24
    v_lshlrev_b32 v14, 16, v25
    s_waitcnt vmcnt(9)
    s_add_u32 m0, s60, 4096
    s_nop 0
    buffer_load_dwordx4 v60, s[8:11], s16 offen offset:0 sc1 nt lds
    buffer_load_dwordx4 v61, s[8:11], s16 offen offset:1024 sc1 nt lds
    v_and_b32 v15, 0xffff0000, v25
    v_mul_f32 v12, s34, v12
    v_mul_f32 v13, s34, v13
    v_mul_f32 v14, s34, v14
    v_mul_f32 v15, s34, v15
    v_exp_f32 v12, v12
    v_exp_f32 v13, v13
    v_exp_f32 v14, v14
    v_exp_f32 v15, v15
    s_nop 0
    v_cvt_pk_bf16_f32 v24, v12, v13
    v_cvt_pk_bf16_f32 v25, v14, v15
    v_lshlrev_b32 v12, 16, v24
    v_and_b32 v13, 0xffff0000, v24
    v_lshlrev_b32 v14, 16, v25
    v_and_b32 v15, 0xffff0000, v25
    v_mul_f32 v12, s35, v12
    v_mul_f32 v13, s35, v13
    v_mul_f32 v14, s35, v14
    v_mul_f32 v15, s35, v15
    v_cvt_pk_bf16_f32 v24, v12, v13
    v_cvt_pk_bf16_f32 v25, v14, v15
    v_lshlrev_b32 v12, 16, v24
    v_and_b32 v13, 0xffff0000, v24
    v_lshlrev_b32 v14, 16, v25
    v_and_b32 v15, 0xffff0000, v25
    v_add_f32 v12, s36, v12
    v_add_f32 v13, s36, v13
    v_add_f32 v14, s36, v14
    v_add_f32 v15, s36, v15
    v_cvt_pk_bf16_f32 v24, v12, v13
    v_cvt_pk_bf16_f32 v25, v14, v15
    ds_write_b64 v1, v[24:25] offset:512
    s_waitcnt vmcnt(9)
    ds_read_b128 a[0:3], v52 offset:16384
    ds_read_b128 a[4:7], v53 offset:16384
    ds_read_b128 a[8:11], v54 offset:16384
    ds_read_b128 a[12:15], v55 offset:16384
    ds_read_b128 a[16:19], v52 offset:16640
    ds_read_b128 a[20:23], v53 offset:16640
    ds_read_b128 a[24:27], v54 offset:16640
    ds_read_b128 a[28:31], v55 offset:16640
    s_add_u32 m0, s60, 6144
    s_nop 0
    buffer_load_dwordx4 v62, s[8:11], s16 offen offset:0 sc1 nt lds
    buffer_load_dwordx4 v63, s[8:11], s16 offen offset:1024 sc1 nt lds
    s_waitcnt lgkmcnt(7)
    v_mfma_f32_16x16x32_bf16 v[12:15], a[0:3], a[32:35], 0
    v_mfma_f32_16x16x32_bf16 v[16:19], a[0:3], a[0:3], 0
    s_waitcnt lgkmcnt(6)
    v_mfma_f32_16x16x32_bf16 v[12:15], a[4:7], a[36:39], v[12:15]
    v_mfma_f32_16x16x32_bf16 v[16:19], a[4:7], a[4:7], v[16:19]
    s_waitcnt lgkmcnt(5)
    v_mfma_f32_16x16x32_bf16 v[12:15], a[8:11], a[40:43], v[12:15]
    v_mfma_f32_16x16x32_bf16 v[16:19], a[8:11], a[8:11], v[16:19]
    s_waitcnt lgkmcnt(4)
    v_mfma_f32_16x16x32_bf16 v[12:15], a[12:15], a[44:47], v[12:15]
    v_mfma_f32_16x16x32_bf16 v[16:19], a[12:15], a[12:15], v[16:19]
    s_waitcnt lgkmcnt(3)
    v_mfma_f32_16x16x32_bf16 v[12:15], a[16:19], a[48:51], v[12:15]
    s_waitcnt vmcnt(9)
    s_and_b32 s16, s17, 63
    s_lshl_b32 s16, s16, 15
    s_add_u32 s16, s16, s39
    s_xor_b32 s3, s17, s19
    s_and_b32 s3, s3, 1
    s_lshl_b32 s3, s3, 13
    s_add_u32 s16, s16, s3
    s_add_u32 s17, s17, 1
    s_add_u32 m0, s60, 8192
    s_nop 0
    buffer_load_dwordx4 v56, s[8:11], s16 offen offset:0 sc1 nt lds
    buffer_load_dwordx4 v57, s[8:11], s16 offen offset:1024 sc1 nt lds
    v_mfma_f32_16x16x32_bf16 v[16:19], a[16:19], a[16:19], v[16:19]
    s_waitcnt lgkmcnt(2)
    v_mfma_f32_16x16x32_bf16 v[12:15], a[20:23], a[52:55], v[12:15]
    v_mfma_f32_16x16x32_bf16 v[16:19], a[20:23], a[20:23], v[16:19]
    s_waitcnt lgkmcnt(1)
    v_mfma_f32_16x16x32_bf16 v[12:15], a[24:27], a[56:59], v[12:15]
    v_mfma_f32_16x16x32_bf16 v[16:19], a[24:27], a[24:27], v[16:19]
    s_waitcnt lgkmcnt(0)
    v_mfma_f32_16x16x32_bf16 v[12:15], a[28:31], a[60:63], v[12:15]
    v_mfma_f32_16x16x32_bf16 v[16:19], a[28:31], a[28:31], v[16:19]
    s_nop 7
    s_waitcnt vmcnt(9)
    s_add_u32 m0, s60, 10240
    s_nop 0
    buffer_load_dwordx4 v58, s[8:11], s16 offen offset:0 sc1 nt lds
    buffer_load_dwordx4 v59, s[8:11], s16 offen offset:1024 sc1 nt lds
    v_cndmask_b32 v5, 0, v16, s[20:21]
    v_cndmask_b32 v5, v5, v17, s[22:23]
    v_cndmask_b32 v5, v5, v18, s[24:25]
    v_cndmask_b32 v5, v5, v19, s[26:27]
    s_nop 1
    v_mfma_f32_16x16x4_f32 v[20:23], v5, v4, 0
    v_mul_f32 v12, s37, v12
    v_mul_f32 v13, s37, v13
    v_mul_f32 v14, s37, v14
    v_mul_f32 v15, s37, v15
    v_cvt_pk_bf16_f32 v24, v12, v13
    v_cvt_pk_bf16_f32 v25, v14, v15
    v_lshlrev_b32 v12, 16, v24
    v_and_b32 v13, 0xffff0000, v24
    v_lshlrev_b32 v14, 16, v25
    v_and_b32 v15, 0xffff0000, v25
    v_cvt_pk_bf16_f32 v24, v20, v21
    v_cvt_pk_bf16_f32 v25, v22, v23
    v_lshlrev_b32 v28, 16, v24
    v_and_b32 v29, 0xffff0000, v24
    v_lshlrev_b32 v30, 16, v25
    v_and_b32 v31, 0xffff0000, v25
    v_sub_f32 v12, v12, v28
    v_sub_f32 v13, v13, v29
    v_sub_f32 v14, v14, v30
    v_sub_f32 v15, v15, v31
    v_cvt_pk_bf16_f32 v24, v12, v13
    v_cvt_pk_bf16_f32 v25, v14, v15
    v_lshlrev_b32 v12, 16, v24
    v_and_b32 v13, 0xffff0000, v24
    v_lshlrev_b32 v14, 16, v25
    s_waitcnt vmcnt(9)
    s_add_u32 m0, s60, 12288
    s_nop 0
    buffer_load_dwordx4 v60, s[8:11], s16 offen offset:0 sc1 nt lds
    buffer_load_dwordx4 v61, s[8:11], s16 offen offset:1024 sc1 nt lds
    v_and_b32 v15, 0xffff0000, v25
    v_mul_f32 v12, s34, v12
    v_mul_f32 v13, s34, v13
    v_mul_f32 v14, s34, v14
    v_mul_f32 v15, s34, v15
    v_exp_f32 v12, v12
    v_exp_f32 v13, v13
    v_exp_f32 v14, v14
    v_exp_f32 v15, v15
    s_nop 0
    v_cvt_pk_bf16_f32 v24, v12, v13
    v_cvt_pk_bf16_f32 v25, v14, v15
    v_lshlrev_b32 v12, 16, v24
    v_and_b32 v13, 0xffff0000, v24
    v_lshlrev_b32 v14, 16, v25
    v_and_b32 v15, 0xffff0000, v25
    v_mul_f32 v12, s35, v12
    v_mul_f32 v13, s35, v13
    v_mul_f32 v14, s35, v14
    v_mul_f32 v15, s35, v15
    v_cvt_pk_bf16_f32 v24, v12, v13
    v_cvt_pk_bf16_f32 v25, v14, v15
    v_lshlrev_b32 v12, 16, v24
    v_and_b32 v13, 0xffff0000, v24
    v_lshlrev_b32 v14, 16, v25
    v_and_b32 v15, 0xffff0000, v25
    v_add_f32 v12, s36, v12
    v_add_f32 v13, s36, v13
    v_add_f32 v14, s36, v14
    v_add_f32 v15, s36, v15
    v_cvt_pk_bf16_f32 v24, v12, v13
    v_cvt_pk_bf16_f32 v25, v14, v15
    ds_write_b64 v1, v[24:25] offset:1024
    s_waitcnt vmcnt(9)
    ds_read_b128 a[0:3], v52 offset:24576
    ds_read_b128 a[4:7], v53 offset:24576
    ds_read_b128 a[8:11], v54 offset:24576
    ds_read_b128 a[12:15], v55 offset:24576
    ds_read_b128 a[16:19], v52 offset:24832
    ds_read_b128 a[20:23], v53 offset:24832
    ds_read_b128 a[24:27], v54 offset:24832
    ds_read_b128 a[28:31], v55 offset:24832
    s_add_u32 m0, s60, 14336
    s_nop 0
    buffer_load_dwordx4 v62, s[8:11], s16 offen offset:0 sc1 nt lds
    buffer_load_dwordx4 v63, s[8:11], s16 offen offset:1024 sc1 nt lds
    s_waitcnt lgkmcnt(7)
    v_mfma_f32_16x16x32_bf16 v[12:15], a[0:3], a[32:35], 0
    v_mfma_f32_16x16x32_bf16 v[16:19], a[0:3], a[0:3], 0
    s_waitcnt lgkmcnt(6)
    v_mfma_f32_16x16x32_bf16 v[12:15], a[4:7], a[36:39], v[12:15]
    v_mfma_f32_16x16x32_bf16 v[16:19], a[4:7], a[4:7], v[16:19]
    s_waitcnt lgkmcnt(5)
    v_mfma_f32_16x16x32_bf16 v[12:15], a[8:11], a[40:43], v[12:15]
    v_mfma_f32_16x16x32_bf16 v[16:19], a[8:11], a[8:11], v[16:19]
    s_waitcnt lgkmcnt(4)
    v_mfma_f32_16x16x32_bf16 v[12:15], a[12:15], a[44:47], v[12:15]
    v_mfma_f32_16x16x32_bf16 v[16:19], a[12:15], a[12:15], v[16:19]
    s_waitcnt lgkmcnt(3)
    v_mfma_f32_16x16x32_bf16 v[12:15], a[16:19], a[48:51], v[12:15]
    s_waitcnt vmcnt(9)
    s_and_b32 s16, s17, 63
    s_lshl_b32 s16, s16, 15
    s_add_u32 s16, s16, s39
    s_xor_b32 s3, s17, s19
    s_and_b32 s3, s3, 1
    s_lshl_b32 s3, s3, 13
    s_add_u32 s16, s16, s3
    s_add_u32 s17, s17, 1
    s_add_u32 m0, s60, 16384
    s_nop 0
    buffer_load_dwordx4 v56, s[8:11], s16 offen offset:0 sc1 nt lds
    buffer_load_dwordx4 v57, s[8:11], s16 offen offset:1024 sc1 nt lds
    v_mfma_f32_16x16x32_bf16 v[16:19], a[16:19], a[16:19], v[16:19]
    s_waitcnt lgkmcnt(2)
    v_mfma_f32_16x16x32_bf16 v[12:15], a[20:23], a[52:55], v[12:15]
    v_mfma_f32_16x16x32_bf16 v[16:19], a[20:23], a[20:23], v[16:19]
    s_waitcnt lgkmcnt(1)
    v_mfma_f32_16x16x32_bf16 v[12:15], a[24:27], a[56:59], v[12:15]
    v_mfma_f32_16x16x32_bf16 v[16:19], a[24:27], a[24:27], v[16:19]
    s_waitcnt lgkmcnt(0)
    v_mfma_f32_16x16x32_bf16 v[12:15], a[28:31], a[60:63], v[12:15]
    v_mfma_f32_16x16x32_bf16 v[16:19], a[28:31], a[28:31], v[16:19]
    s_nop 7
    s_waitcnt vmcnt(9)
    s_add_u32 m0, s60, 18432
    s_nop 0
    buffer_load_dwordx4 v58, s[8:11], s16 offen offset:0 sc1 nt lds
    buffer_load_dwordx4 v59, s[8:11], s16 offen offset:1024 sc1 nt lds
    v_cndmask_b32 v5, 0, v16, s[20:21]
    v_cndmask_b32 v5, v5, v17, s[22:23]
    v_cndmask_b32 v5, v5, v18, s[24:25]
    v_cndmask_b32 v5, v5, v19, s[26:27]
    s_nop 1
    v_mfma_f32_16x16x4_f32 v[20:23], v5, v4, 0
    v_mul_f32 v12, s37, v12
    v_mul_f32 v13, s37, v13
    v_mul_f32 v14, s37, v14
    v_mul_f32 v15, s37, v15
    v_cvt_pk_bf16_f32 v24, v12, v13
    v_cvt_pk_bf16_f32 v25, v14, v15
    v_lshlrev_b32 v12, 16, v24
    v_and_b32 v13, 0xffff0000, v24
    v_lshlrev_b32 v14, 16, v25
    v_and_b32 v15, 0xffff0000, v25
    v_cvt_pk_bf16_f32 v24, v20, v21
    v_cvt_pk_bf16_f32 v25, v22, v23
    v_lshlrev_b32 v28, 16, v24
    v_and_b32 v29, 0xffff0000, v24
    v_lshlrev_b32 v30, 16, v25
    v_and_b32 v31, 0xffff0000, v25
    v_sub_f32 v12, v12, v28
    v_sub_f32 v13, v13, v29
    v_sub_f32 v14, v14, v30
    v_sub_f32 v15, v15, v31
    v_cvt_pk_bf16_f32 v24, v12, v13
    v_cvt_pk_bf16_f32 v25, v14, v15
    v_lshlrev_b32 v12, 16, v24
    v_and_b32 v13, 0xffff0000, v24
    v_lshlrev_b32 v14, 16, v25
    s_waitcnt vmcnt(9)
    s_add_u32 m0, s60, 20480
    s_nop 0
    buffer_load_dwordx4 v60, s[8:11], s16 offen offset:0 sc1 nt lds
    buffer_load_dwordx4 v61, s[8:11], s16 offen offset:1024 sc1 nt lds
    v_and_b32 v15, 0xffff0000, v25
    v_mul_f32 v12, s34, v12
    v_mul_f32 v13, s34, v13
    v_mul_f32 v14, s34, v14
    v_mul_f32 v15, s34, v15
    v_exp_f32 v12, v12
    v_exp_f32 v13, v13
    v_exp_f32 v14, v14
    v_exp_f32 v15, v15
    s_nop 0
    v_cvt_pk_bf16_f32 v24, v12, v13
    v_cvt_pk_bf16_f32 v25, v14, v15
    v_lshlrev_b32 v12, 16, v24
    v_and_b32 v13, 0xffff0000, v24
    v_lshlrev_b32 v14, 16, v25
    v_and_b32 v15, 0xffff0000, v25
    v_mul_f32 v12, s35, v12
    v_mul_f32 v13, s35, v13
    v_mul_f32 v14, s35, v14
    v_mul_f32 v15, s35, v15
    v_cvt_pk_bf16_f32 v24, v12, v13
    v_cvt_pk_bf16_f32 v25, v14, v15
    v_lshlrev_b32 v12, 16, v24
    v_and_b32 v13, 0xffff0000, v24
    v_lshlrev_b32 v14, 16, v25
    v_and_b32 v15, 0xffff0000, v25
    v_add_f32 v12, s36, v12
    v_add_f32 v13, s36, v13
    v_add_f32 v14, s36, v14
    v_add_f32 v15, s36, v15
    v_cvt_pk_bf16_f32 v24, v12, v13
    v_cvt_pk_bf16_f32 v25, v14, v15
    ds_write_b64 v1, v[24:25] offset:1536
    v_add_u32 v1, 2048, v1
    s_sub_u32 s18, s18, 1
    s_cmp_lg_u32 s18, 0
    s_cbranch_scc1 L_kloop_standalone__linear_kernel_rfa__decode_kernel
    s_waitcnt vmcnt(9)
    ds_read_b128 a[0:3], v52 offset:0
    ds_read_b128 a[4:7], v53 offset:0
    ds_read_b128 a[8:11], v54 offset:0
    ds_read_b128 a[12:15], v55 offset:0
    ds_read_b128 a[16:19], v52 offset:256
    ds_read_b128 a[20:23], v53 offset:256
    ds_read_b128 a[24:27], v54 offset:256
    ds_read_b128 a[28:31], v55 offset:256
    s_add_u32 m0, s60, 22528
    s_nop 0
    buffer_load_dwordx4 v62, s[8:11], s16 offen offset:0 sc1 nt lds
    buffer_load_dwordx4 v63, s[8:11], s16 offen offset:1024 sc1 nt lds
    s_waitcnt lgkmcnt(7)
    v_mfma_f32_16x16x32_bf16 v[12:15], a[0:3], a[32:35], 0
    v_mfma_f32_16x16x32_bf16 v[16:19], a[0:3], a[0:3], 0
    s_waitcnt lgkmcnt(6)
    v_mfma_f32_16x16x32_bf16 v[12:15], a[4:7], a[36:39], v[12:15]
    v_mfma_f32_16x16x32_bf16 v[16:19], a[4:7], a[4:7], v[16:19]
    s_waitcnt lgkmcnt(5)
    v_mfma_f32_16x16x32_bf16 v[12:15], a[8:11], a[40:43], v[12:15]
    v_mfma_f32_16x16x32_bf16 v[16:19], a[8:11], a[8:11], v[16:19]
    s_waitcnt lgkmcnt(4)
    v_mfma_f32_16x16x32_bf16 v[12:15], a[12:15], a[44:47], v[12:15]
    v_mfma_f32_16x16x32_bf16 v[16:19], a[12:15], a[12:15], v[16:19]
    s_waitcnt lgkmcnt(3)
    v_mfma_f32_16x16x32_bf16 v[12:15], a[16:19], a[48:51], v[12:15]
    s_waitcnt vmcnt(9)
    s_and_b32 s16, s17, 63
    s_lshl_b32 s16, s16, 15
    s_add_u32 s16, s16, s39
    s_xor_b32 s3, s17, s19
    s_and_b32 s3, s3, 1
    s_lshl_b32 s3, s3, 13
    s_add_u32 s16, s16, s3
    s_add_u32 s17, s17, 1
    s_add_u32 m0, s60, 24576
    s_nop 0
    buffer_load_dwordx4 v56, s[8:11], s16 offen offset:0 sc1 nt lds
    buffer_load_dwordx4 v57, s[8:11], s16 offen offset:1024 sc1 nt lds
    v_mfma_f32_16x16x32_bf16 v[16:19], a[16:19], a[16:19], v[16:19]
    s_waitcnt lgkmcnt(2)
    v_mfma_f32_16x16x32_bf16 v[12:15], a[20:23], a[52:55], v[12:15]
    v_mfma_f32_16x16x32_bf16 v[16:19], a[20:23], a[20:23], v[16:19]
    s_waitcnt lgkmcnt(1)
    v_mfma_f32_16x16x32_bf16 v[12:15], a[24:27], a[56:59], v[12:15]
    v_mfma_f32_16x16x32_bf16 v[16:19], a[24:27], a[24:27], v[16:19]
    s_waitcnt lgkmcnt(0)
    v_mfma_f32_16x16x32_bf16 v[12:15], a[28:31], a[60:63], v[12:15]
    v_mfma_f32_16x16x32_bf16 v[16:19], a[28:31], a[28:31], v[16:19]
    s_nop 7
    s_waitcnt vmcnt(9)
    s_add_u32 m0, s60, 26624
    s_nop 0
    buffer_load_dwordx4 v58, s[8:11], s16 offen offset:0 sc1 nt lds
    buffer_load_dwordx4 v59, s[8:11], s16 offen offset:1024 sc1 nt lds
    v_cndmask_b32 v5, 0, v16, s[20:21]
    v_cndmask_b32 v5, v5, v17, s[22:23]
    v_cndmask_b32 v5, v5, v18, s[24:25]
    v_cndmask_b32 v5, v5, v19, s[26:27]
    s_nop 1
    v_mfma_f32_16x16x4_f32 v[20:23], v5, v4, 0
    v_mul_f32 v12, s37, v12
    v_mul_f32 v13, s37, v13
    v_mul_f32 v14, s37, v14
    v_mul_f32 v15, s37, v15
    v_cvt_pk_bf16_f32 v24, v12, v13
    v_cvt_pk_bf16_f32 v25, v14, v15
    v_lshlrev_b32 v12, 16, v24
    v_and_b32 v13, 0xffff0000, v24
    v_lshlrev_b32 v14, 16, v25
    v_and_b32 v15, 0xffff0000, v25
    v_cvt_pk_bf16_f32 v24, v20, v21
    v_cvt_pk_bf16_f32 v25, v22, v23
    v_lshlrev_b32 v28, 16, v24
    v_and_b32 v29, 0xffff0000, v24
    v_lshlrev_b32 v30, 16, v25
    v_and_b32 v31, 0xffff0000, v25
    v_sub_f32 v12, v12, v28
    v_sub_f32 v13, v13, v29
    v_sub_f32 v14, v14, v30
    v_sub_f32 v15, v15, v31
    v_cvt_pk_bf16_f32 v24, v12, v13
    v_cvt_pk_bf16_f32 v25, v14, v15
    v_lshlrev_b32 v12, 16, v24
    v_and_b32 v13, 0xffff0000, v24
    v_lshlrev_b32 v14, 16, v25
    s_waitcnt vmcnt(9)
    s_add_u32 m0, s60, 28672
    s_nop 0
    buffer_load_dwordx4 v60, s[8:11], s16 offen offset:0 sc1 nt lds
    buffer_load_dwordx4 v61, s[8:11], s16 offen offset:1024 sc1 nt lds
    v_and_b32 v15, 0xffff0000, v25
    v_mul_f32 v12, s34, v12
    v_mul_f32 v13, s34, v13
    v_mul_f32 v14, s34, v14
    v_mul_f32 v15, s34, v15
    v_exp_f32 v12, v12
    v_exp_f32 v13, v13
    v_exp_f32 v14, v14
    v_exp_f32 v15, v15
    s_nop 0
    v_cvt_pk_bf16_f32 v24, v12, v13
    v_cvt_pk_bf16_f32 v25, v14, v15
    v_lshlrev_b32 v12, 16, v24
    v_and_b32 v13, 0xffff0000, v24
    v_lshlrev_b32 v14, 16, v25
    v_and_b32 v15, 0xffff0000, v25
    v_mul_f32 v12, s35, v12
    v_mul_f32 v13, s35, v13
    v_mul_f32 v14, s35, v14
    v_mul_f32 v15, s35, v15
    v_cvt_pk_bf16_f32 v24, v12, v13
    v_cvt_pk_bf16_f32 v25, v14, v15
    v_lshlrev_b32 v12, 16, v24
    v_and_b32 v13, 0xffff0000, v24
    v_lshlrev_b32 v14, 16, v25
    v_and_b32 v15, 0xffff0000, v25
    v_add_f32 v12, s36, v12
    v_add_f32 v13, s36, v13
    v_add_f32 v14, s36, v14
    v_add_f32 v15, s36, v15
    v_cvt_pk_bf16_f32 v24, v12, v13
    v_cvt_pk_bf16_f32 v25, v14, v15
    ds_write_b64 v1, v[24:25] offset:0
    s_waitcnt vmcnt(9)
    ds_read_b128 a[0:3], v52 offset:8192
    ds_read_b128 a[4:7], v53 offset:8192
    ds_read_b128 a[8:11], v54 offset:8192
    ds_read_b128 a[12:15], v55 offset:8192
    ds_read_b128 a[16:19], v52 offset:8448
    ds_read_b128 a[20:23], v53 offset:8448
    ds_read_b128 a[24:27], v54 offset:8448
    ds_read_b128 a[28:31], v55 offset:8448
    s_add_u32 m0, s60, 30720
    s_nop 0
    buffer_load_dwordx4 v62, s[8:11], s16 offen offset:0 sc1 nt lds
    buffer_load_dwordx4 v63, s[8:11], s16 offen offset:1024 sc1 nt lds
    s_waitcnt lgkmcnt(7)
    v_mfma_f32_16x16x32_bf16 v[12:15], a[0:3], a[32:35], 0
    v_mfma_f32_16x16x32_bf16 v[16:19], a[0:3], a[0:3], 0
    s_waitcnt lgkmcnt(6)
    v_mfma_f32_16x16x32_bf16 v[12:15], a[4:7], a[36:39], v[12:15]
    v_mfma_f32_16x16x32_bf16 v[16:19], a[4:7], a[4:7], v[16:19]
    s_waitcnt lgkmcnt(5)
    v_mfma_f32_16x16x32_bf16 v[12:15], a[8:11], a[40:43], v[12:15]
    v_mfma_f32_16x16x32_bf16 v[16:19], a[8:11], a[8:11], v[16:19]
    s_waitcnt lgkmcnt(4)
    v_mfma_f32_16x16x32_bf16 v[12:15], a[12:15], a[44:47], v[12:15]
    v_mfma_f32_16x16x32_bf16 v[16:19], a[12:15], a[12:15], v[16:19]
    s_waitcnt lgkmcnt(3)
    v_mfma_f32_16x16x32_bf16 v[12:15], a[16:19], a[48:51], v[12:15]
    s_waitcnt vmcnt(8)
    s_and_b32 s16, s17, 63
    s_lshl_b32 s16, s16, 15
    s_add_u32 s16, s16, s39
    s_xor_b32 s3, s17, s19
    s_and_b32 s3, s3, 1
    s_lshl_b32 s3, s3, 13
    s_add_u32 s16, s16, s3
    s_add_u32 s17, s17, 1
    buffer_load_dwordx4 v[100:103], v2, s[12:15], s16 offen offset:0 sc1 nt
    buffer_load_dwordx4 v[104:107], v2, s[12:15], s16 offen offset:1024 sc1 nt
    v_mfma_f32_16x16x32_bf16 v[16:19], a[16:19], a[16:19], v[16:19]
    s_waitcnt lgkmcnt(2)
    v_mfma_f32_16x16x32_bf16 v[12:15], a[20:23], a[52:55], v[12:15]
    v_mfma_f32_16x16x32_bf16 v[16:19], a[20:23], a[20:23], v[16:19]
    s_waitcnt lgkmcnt(1)
    v_mfma_f32_16x16x32_bf16 v[12:15], a[24:27], a[56:59], v[12:15]
    v_mfma_f32_16x16x32_bf16 v[16:19], a[24:27], a[24:27], v[16:19]
    s_waitcnt lgkmcnt(0)
    v_mfma_f32_16x16x32_bf16 v[12:15], a[28:31], a[60:63], v[12:15]
    v_mfma_f32_16x16x32_bf16 v[16:19], a[28:31], a[28:31], v[16:19]
    s_nop 7
    s_waitcnt vmcnt(9)
    buffer_load_dwordx4 v[108:111], v2, s[12:15], s16 offen offset:2048 sc1 nt
    buffer_load_dwordx4 v[112:115], v2, s[12:15], s16 offen offset:3072 sc1 nt
    v_cndmask_b32 v5, 0, v16, s[20:21]
    v_cndmask_b32 v5, v5, v17, s[22:23]
    v_cndmask_b32 v5, v5, v18, s[24:25]
    v_cndmask_b32 v5, v5, v19, s[26:27]
    s_nop 1
    v_mfma_f32_16x16x4_f32 v[20:23], v5, v4, 0
    v_mul_f32 v12, s37, v12
    v_mul_f32 v13, s37, v13
    v_mul_f32 v14, s37, v14
    v_mul_f32 v15, s37, v15
    v_cvt_pk_bf16_f32 v24, v12, v13
    v_cvt_pk_bf16_f32 v25, v14, v15
    v_lshlrev_b32 v12, 16, v24
    v_and_b32 v13, 0xffff0000, v24
    v_lshlrev_b32 v14, 16, v25
    v_and_b32 v15, 0xffff0000, v25
    v_cvt_pk_bf16_f32 v24, v20, v21
    v_cvt_pk_bf16_f32 v25, v22, v23
    v_lshlrev_b32 v28, 16, v24
    v_and_b32 v29, 0xffff0000, v24
    v_lshlrev_b32 v30, 16, v25
    v_and_b32 v31, 0xffff0000, v25
    v_sub_f32 v12, v12, v28
    v_sub_f32 v13, v13, v29
    v_sub_f32 v14, v14, v30
    v_sub_f32 v15, v15, v31
    v_cvt_pk_bf16_f32 v24, v12, v13
    v_cvt_pk_bf16_f32 v25, v14, v15
    v_lshlrev_b32 v12, 16, v24
    v_and_b32 v13, 0xffff0000, v24
    v_lshlrev_b32 v14, 16, v25
    s_waitcnt vmcnt(8)
    buffer_load_dwordx4 v[116:119], v3, s[12:15], s16 offen offset:0 sc1 nt
    buffer_load_dwordx4 v[120:123], v3, s[12:15], s16 offen offset:1024 sc1 nt
    v_and_b32 v15, 0xffff0000, v25
    v_mul_f32 v12, s34, v12
    v_mul_f32 v13, s34, v13
    v_mul_f32 v14, s34, v14
    v_mul_f32 v15, s34, v15
    v_exp_f32 v12, v12
    v_exp_f32 v13, v13
    v_exp_f32 v14, v14
    v_exp_f32 v15, v15
    s_nop 0
    v_cvt_pk_bf16_f32 v24, v12, v13
    v_cvt_pk_bf16_f32 v25, v14, v15
    v_lshlrev_b32 v12, 16, v24
    v_and_b32 v13, 0xffff0000, v24
    v_lshlrev_b32 v14, 16, v25
    v_and_b32 v15, 0xffff0000, v25
    v_mul_f32 v12, s35, v12
    v_mul_f32 v13, s35, v13
    v_mul_f32 v14, s35, v14
    v_mul_f32 v15, s35, v15
    v_cvt_pk_bf16_f32 v24, v12, v13
    v_cvt_pk_bf16_f32 v25, v14, v15
    v_lshlrev_b32 v12, 16, v24
    v_and_b32 v13, 0xffff0000, v24
    v_lshlrev_b32 v14, 16, v25
    v_and_b32 v15, 0xffff0000, v25
    v_add_f32 v12, s36, v12
    v_add_f32 v13, s36, v13
    v_add_f32 v14, s36, v14
    v_add_f32 v15, s36, v15
    v_cvt_pk_bf16_f32 v24, v12, v13
    v_cvt_pk_bf16_f32 v25, v14, v15
    ds_write_b64 v1, v[24:25] offset:512
    s_waitcnt vmcnt(9)
    ds_read_b128 a[0:3], v52 offset:16384
    ds_read_b128 a[4:7], v53 offset:16384
    ds_read_b128 a[8:11], v54 offset:16384
    ds_read_b128 a[12:15], v55 offset:16384
    ds_read_b128 a[16:19], v52 offset:16640
    ds_read_b128 a[20:23], v53 offset:16640
    ds_read_b128 a[24:27], v54 offset:16640
    ds_read_b128 a[28:31], v55 offset:16640
    buffer_load_dwordx4 v[124:127], v3, s[12:15], s16 offen offset:2048 sc1 nt
    buffer_load_dwordx4 v[128:131], v3, s[12:15], s16 offen offset:3072 sc1 nt
    s_waitcnt lgkmcnt(7)
    v_mfma_f32_16x16x32_bf16 v[12:15], a[0:3], a[32:35], 0
    v_mfma_f32_16x16x32_bf16 v[16:19], a[0:3], a[0:3], 0
    s_waitcnt lgkmcnt(6)
    v_mfma_f32_16x16x32_bf16 v[12:15], a[4:7], a[36:39], v[12:15]
    v_mfma_f32_16x16x32_bf16 v[16:19], a[4:7], a[4:7], v[16:19]
    s_waitcnt lgkmcnt(5)
    v_mfma_f32_16x16x32_bf16 v[12:15], a[8:11], a[40:43], v[12:15]
    v_mfma_f32_16x16x32_bf16 v[16:19], a[8:11], a[8:11], v[16:19]
    s_waitcnt lgkmcnt(4)
    v_mfma_f32_16x16x32_bf16 v[12:15], a[12:15], a[44:47], v[12:15]
    v_mfma_f32_16x16x32_bf16 v[16:19], a[12:15], a[12:15], v[16:19]
    s_waitcnt lgkmcnt(3)
    v_mfma_f32_16x16x32_bf16 v[12:15], a[16:19], a[48:51], v[12:15]
    s_waitcnt vmcnt(8)
    s_and_b32 s16, s17, 63
    s_lshl_b32 s16, s16, 15
    s_add_u32 s16, s16, s39
    s_xor_b32 s3, s17, s19
    s_and_b32 s3, s3, 1
    s_lshl_b32 s3, s3, 13
    s_add_u32 s16, s16, s3
    s_add_u32 s17, s17, 1
    buffer_load_dwordx4 v[132:135], v2, s[12:15], s16 offen offset:0 sc1 nt
    buffer_load_dwordx4 v[136:139], v2, s[12:15], s16 offen offset:1024 sc1 nt
    v_mfma_f32_16x16x32_bf16 v[16:19], a[16:19], a[16:19], v[16:19]
    s_waitcnt lgkmcnt(2)
    v_mfma_f32_16x16x32_bf16 v[12:15], a[20:23], a[52:55], v[12:15]
    v_mfma_f32_16x16x32_bf16 v[16:19], a[20:23], a[20:23], v[16:19]
    s_waitcnt lgkmcnt(1)
    v_mfma_f32_16x16x32_bf16 v[12:15], a[24:27], a[56:59], v[12:15]
    v_mfma_f32_16x16x32_bf16 v[16:19], a[24:27], a[24:27], v[16:19]
    s_waitcnt lgkmcnt(0)
    v_mfma_f32_16x16x32_bf16 v[12:15], a[28:31], a[60:63], v[12:15]
    v_mfma_f32_16x16x32_bf16 v[16:19], a[28:31], a[28:31], v[16:19]
    s_nop 7
    s_waitcnt vmcnt(9)
    buffer_load_dwordx4 v[140:143], v2, s[12:15], s16 offen offset:2048 sc1 nt
    buffer_load_dwordx4 v[144:147], v2, s[12:15], s16 offen offset:3072 sc1 nt
    v_cndmask_b32 v5, 0, v16, s[20:21]
    v_cndmask_b32 v5, v5, v17, s[22:23]
    v_cndmask_b32 v5, v5, v18, s[24:25]
    v_cndmask_b32 v5, v5, v19, s[26:27]
    s_nop 1
    v_mfma_f32_16x16x4_f32 v[20:23], v5, v4, 0
    v_mul_f32 v12, s37, v12
    v_mul_f32 v13, s37, v13
    v_mul_f32 v14, s37, v14
    v_mul_f32 v15, s37, v15
    v_cvt_pk_bf16_f32 v24, v12, v13
    v_cvt_pk_bf16_f32 v25, v14, v15
    v_lshlrev_b32 v12, 16, v24
    v_and_b32 v13, 0xffff0000, v24
    v_lshlrev_b32 v14, 16, v25
    v_and_b32 v15, 0xffff0000, v25
    v_cvt_pk_bf16_f32 v24, v20, v21
    v_cvt_pk_bf16_f32 v25, v22, v23
    v_lshlrev_b32 v28, 16, v24
    v_and_b32 v29, 0xffff0000, v24
    v_lshlrev_b32 v30, 16, v25
    v_and_b32 v31, 0xffff0000, v25
    v_sub_f32 v12, v12, v28
    v_sub_f32 v13, v13, v29
    v_sub_f32 v14, v14, v30
    v_sub_f32 v15, v15, v31
    v_cvt_pk_bf16_f32 v24, v12, v13
    v_cvt_pk_bf16_f32 v25, v14, v15
    v_lshlrev_b32 v12, 16, v24
    v_and_b32 v13, 0xffff0000, v24
    v_lshlrev_b32 v14, 16, v25
    s_waitcnt vmcnt(8)
    buffer_load_dwordx4 v[148:151], v3, s[12:15], s16 offen offset:0 sc1 nt
    buffer_load_dwordx4 v[152:155], v3, s[12:15], s16 offen offset:1024 sc1 nt
    v_and_b32 v15, 0xffff0000, v25
    v_mul_f32 v12, s34, v12
    v_mul_f32 v13, s34, v13
    v_mul_f32 v14, s34, v14
    v_mul_f32 v15, s34, v15
    v_exp_f32 v12, v12
    v_exp_f32 v13, v13
    v_exp_f32 v14, v14
    v_exp_f32 v15, v15
    s_nop 0
    v_cvt_pk_bf16_f32 v24, v12, v13
    v_cvt_pk_bf16_f32 v25, v14, v15
    v_lshlrev_b32 v12, 16, v24
    v_and_b32 v13, 0xffff0000, v24
    v_lshlrev_b32 v14, 16, v25
    v_and_b32 v15, 0xffff0000, v25
    v_mul_f32 v12, s35, v12
    v_mul_f32 v13, s35, v13
    v_mul_f32 v14, s35, v14
    v_mul_f32 v15, s35, v15
    v_cvt_pk_bf16_f32 v24, v12, v13
    v_cvt_pk_bf16_f32 v25, v14, v15
    v_lshlrev_b32 v12, 16, v24
    v_and_b32 v13, 0xffff0000, v24
    v_lshlrev_b32 v14, 16, v25
    v_and_b32 v15, 0xffff0000, v25
    v_add_f32 v12, s36, v12
    v_add_f32 v13, s36, v13
    v_add_f32 v14, s36, v14
    v_add_f32 v15, s36, v15
    v_cvt_pk_bf16_f32 v24, v12, v13
    v_cvt_pk_bf16_f32 v25, v14, v15
    ds_write_b64 v1, v[24:25] offset:1024
    s_waitcnt vmcnt(9)
    ds_read_b128 a[0:3], v52 offset:24576
    ds_read_b128 a[4:7], v53 offset:24576
    ds_read_b128 a[8:11], v54 offset:24576
    ds_read_b128 a[12:15], v55 offset:24576
    ds_read_b128 a[16:19], v52 offset:24832
    ds_read_b128 a[20:23], v53 offset:24832
    ds_read_b128 a[24:27], v54 offset:24832
    ds_read_b128 a[28:31], v55 offset:24832
    buffer_load_dwordx4 v[156:159], v3, s[12:15], s16 offen offset:2048 sc1 nt
    buffer_load_dwordx4 v[160:163], v3, s[12:15], s16 offen offset:3072 sc1 nt
    s_waitcnt lgkmcnt(7)
    v_mfma_f32_16x16x32_bf16 v[12:15], a[0:3], a[32:35], 0
    v_mfma_f32_16x16x32_bf16 v[16:19], a[0:3], a[0:3], 0
    s_waitcnt lgkmcnt(6)
    v_mfma_f32_16x16x32_bf16 v[12:15], a[4:7], a[36:39], v[12:15]
    v_mfma_f32_16x16x32_bf16 v[16:19], a[4:7], a[4:7], v[16:19]
    s_waitcnt lgkmcnt(5)
    v_mfma_f32_16x16x32_bf16 v[12:15], a[8:11], a[40:43], v[12:15]
    v_mfma_f32_16x16x32_bf16 v[16:19], a[8:11], a[8:11], v[16:19]
    s_waitcnt lgkmcnt(4)
    v_mfma_f32_16x16x32_bf16 v[12:15], a[12:15], a[44:47], v[12:15]
    v_mfma_f32_16x16x32_bf16 v[16:19], a[12:15], a[12:15], v[16:19]
    s_waitcnt lgkmcnt(3)
    v_mfma_f32_16x16x32_bf16 v[12:15], a[16:19], a[48:51], v[12:15]
    s_waitcnt vmcnt(8)
    s_and_b32 s16, s17, 63
    s_lshl_b32 s16, s16, 15
    s_add_u32 s16, s16, s39
    s_xor_b32 s3, s17, s19
    s_and_b32 s3, s3, 1
    s_lshl_b32 s3, s3, 13
    s_add_u32 s16, s16, s3
    s_add_u32 s17, s17, 1
    buffer_load_dwordx4 v[164:167], v2, s[12:15], s16 offen offset:0 sc1 nt
    buffer_load_dwordx4 v[168:171], v2, s[12:15], s16 offen offset:1024 sc1 nt
    v_mfma_f32_16x16x32_bf16 v[16:19], a[16:19], a[16:19], v[16:19]
    s_waitcnt lgkmcnt(2)
    v_mfma_f32_16x16x32_bf16 v[12:15], a[20:23], a[52:55], v[12:15]
    v_mfma_f32_16x16x32_bf16 v[16:19], a[20:23], a[20:23], v[16:19]
    s_waitcnt lgkmcnt(1)
    v_mfma_f32_16x16x32_bf16 v[12:15], a[24:27], a[56:59], v[12:15]
    v_mfma_f32_16x16x32_bf16 v[16:19], a[24:27], a[24:27], v[16:19]
    s_waitcnt lgkmcnt(0)
    v_mfma_f32_16x16x32_bf16 v[12:15], a[28:31], a[60:63], v[12:15]
    v_mfma_f32_16x16x32_bf16 v[16:19], a[28:31], a[28:31], v[16:19]
    s_nop 7
    s_waitcnt vmcnt(9)
    buffer_load_dwordx4 v[172:175], v2, s[12:15], s16 offen offset:2048 sc1 nt
    buffer_load_dwordx4 v[176:179], v2, s[12:15], s16 offen offset:3072 sc1 nt
    v_cndmask_b32 v5, 0, v16, s[20:21]
    v_cndmask_b32 v5, v5, v17, s[22:23]
    v_cndmask_b32 v5, v5, v18, s[24:25]
    v_cndmask_b32 v5, v5, v19, s[26:27]
    s_nop 1
    v_mfma_f32_16x16x4_f32 v[20:23], v5, v4, 0
    v_mul_f32 v12, s37, v12
    v_mul_f32 v13, s37, v13
    v_mul_f32 v14, s37, v14
    v_mul_f32 v15, s37, v15
    v_cvt_pk_bf16_f32 v24, v12, v13
    v_cvt_pk_bf16_f32 v25, v14, v15
    v_lshlrev_b32 v12, 16, v24
    v_and_b32 v13, 0xffff0000, v24
    v_lshlrev_b32 v14, 16, v25
    v_and_b32 v15, 0xffff0000, v25
    v_cvt_pk_bf16_f32 v24, v20, v21
    v_cvt_pk_bf16_f32 v25, v22, v23
    v_lshlrev_b32 v28, 16, v24
    v_and_b32 v29, 0xffff0000, v24
    v_lshlrev_b32 v30, 16, v25
    v_and_b32 v31, 0xffff0000, v25
    v_sub_f32 v12, v12, v28
    v_sub_f32 v13, v13, v29
    v_sub_f32 v14, v14, v30
    v_sub_f32 v15, v15, v31
    v_cvt_pk_bf16_f32 v24, v12, v13
    v_cvt_pk_bf16_f32 v25, v14, v15
    v_lshlrev_b32 v12, 16, v24
    v_and_b32 v13, 0xffff0000, v24
    v_lshlrev_b32 v14, 16, v25
    s_waitcnt vmcnt(8)
    ds_read_b64 v[48:49], v7 offset:0
    buffer_load_dwordx4 v[180:183], v3, s[12:15], s16 offen offset:0 sc1 nt
    buffer_load_dwordx4 v[184:187], v3, s[12:15], s16 offen offset:1024 sc1 nt
    v_and_b32 v15, 0xffff0000, v25
    v_mul_f32 v12, s34, v12
    v_mul_f32 v13, s34, v13
    v_mul_f32 v14, s34, v14
    v_mul_f32 v15, s34, v15
    v_exp_f32 v12, v12
    v_exp_f32 v13, v13
    v_exp_f32 v14, v14
    v_exp_f32 v15, v15
    s_nop 0
    v_cvt_pk_bf16_f32 v24, v12, v13
    v_cvt_pk_bf16_f32 v25, v14, v15
    v_lshlrev_b32 v12, 16, v24
    v_and_b32 v13, 0xffff0000, v24
    v_lshlrev_b32 v14, 16, v25
    v_and_b32 v15, 0xffff0000, v25
    v_mul_f32 v12, s35, v12
    v_mul_f32 v13, s35, v13
    v_mul_f32 v14, s35, v14
    v_mul_f32 v15, s35, v15
    v_cvt_pk_bf16_f32 v24, v12, v13
    v_cvt_pk_bf16_f32 v25, v14, v15
    v_lshlrev_b32 v12, 16, v24
    v_and_b32 v13, 0xffff0000, v24
    v_lshlrev_b32 v14, 16, v25
    v_and_b32 v15, 0xffff0000, v25
    v_add_f32 v12, s36, v12
    v_add_f32 v13, s36, v13
    v_add_f32 v14, s36, v14
    v_add_f32 v15, s36, v15
    v_cvt_pk_bf16_f32 v24, v12, v13
    v_cvt_pk_bf16_f32 v25, v14, v15
    ds_write_b64 v1, v[24:25] offset:1536
    s_waitcnt vmcnt(9)
    buffer_load_dwordx4 v[188:191], v3, s[12:15], s16 offen offset:2048 sc1 nt
    buffer_load_dwordx4 v[192:195], v3, s[12:15], s16 offen offset:3072 sc1 nt
    s_waitcnt lgkmcnt(0)
    v_cndmask_b32 v32, 0, v48, s[28:29]
    v_cndmask_b32 v33, 0, v49, s[28:29]
    v_cndmask_b32 v34, 0, v48, s[30:31]
    v_cndmask_b32 v35, 0, v49, s[30:31]
    s_nop 1
    v_permlane16_swap_b32 v32, v34
    v_permlane16_swap_b32 v33, v35
    v_mfma_f32_16x16x32_bf16 v[12:15], a[32:35], a[64:67], 0
    v_mfma_f32_16x16x32_bf16 v[16:19], a[64:67], a[64:67], 0
    v_mfma_f32_16x16x32_bf16 v[12:15], a[36:39], a[68:71], v[12:15]
    v_mfma_f32_16x16x32_bf16 v[16:19], a[68:71], a[68:71], v[16:19]
    v_mfma_f32_16x16x32_bf16 v[12:15], a[40:43], a[72:75], v[12:15]
    v_mfma_f32_16x16x32_bf16 v[16:19], a[72:75], a[72:75], v[16:19]
    v_mfma_f32_16x16x32_bf16 v[12:15], a[44:47], a[76:79], v[12:15]
    v_mfma_f32_16x16x32_bf16 v[16:19], a[76:79], a[76:79], v[16:19]
    v_mfma_f32_16x16x32_bf16 v[12:15], a[48:51], a[80:83], v[12:15]
    s_waitcnt vmcnt(8)
    s_and_b32 s16, s17, 63
    s_lshl_b32 s16, s16, 15
    s_add_u32 s16, s16, s39
    s_xor_b32 s3, s17, s19
    s_and_b32 s3, s3, 1
    s_lshl_b32 s3, s3, 13
    s_add_u32 s16, s16, s3
    s_add_u32 s17, s17, 1
    buffer_load_dwordx4 v[196:199], v2, s[12:15], s16 offen offset:0 sc1 nt
    buffer_load_dwordx4 v[200:203], v2, s[12:15], s16 offen offset:1024 sc1 nt
    v_perm_b32 v36, v104, v100, s32
    v_perm_b32 v37, v112, v108, s32
    v_perm_b32 v38, v120, v116, s32
    v_perm_b32 v39, v128, v124, s32
    v_mfma_f32_16x16x32_bf16 v[96:99], v[32:35], v[8:11], v[96:99]
    v_perm_b32 v40, v104, v100, s33
    v_perm_b32 v41, v112, v108, s33
    v_perm_b32 v42, v120, v116, s33
    v_perm_b32 v43, v128, v124, s33
    v_mfma_f32_16x16x32_bf16 v[64:67], v[32:35], v[36:39], v[64:67]
    v_perm_b32 v36, v105, v101, s32
    v_perm_b32 v37, v113, v109, s32
    v_perm_b32 v38, v121, v117, s32
    v_perm_b32 v39, v129, v125, s32
    v_mfma_f32_16x16x32_bf16 v[68:71], v[32:35], v[40:43], v[68:71]
    v_perm_b32 v40, v105, v101, s33
    v_perm_b32 v41, v113, v109, s33
    v_perm_b32 v42, v121, v117, s33
    v_perm_b32 v43, v129, v125, s33
    v_mfma_f32_16x16x32_bf16 v[72:75], v[32:35], v[36:39], v[72:75]
    v_perm_b32 v36, v106, v102, s32
    v_perm_b32 v37, v114, v110, s32
    v_perm_b32 v38, v122, v118, s32
    v_perm_b32 v39, v130, v126, s32
    v_mfma_f32_16x16x32_bf16 v[76:79], v[32:35], v[40:43], v[76:79]
    v_perm_b32 v40, v106, v102, s33
    v_perm_b32 v41, v114, v110, s33
    v_perm_b32 v42, v122, v118, s33
    v_perm_b32 v43, v130, v126, s33
    v_mfma_f32_16x16x32_bf16 v[80:83], v[32:35], v[36:39], v[80:83]
    v_perm_b32 v36, v107, v103, s32
    v_perm_b32 v37, v115, v111, s32
    v_perm_b32 v38, v123, v119, s32
    v_perm_b32 v39, v131, v127, s32
    v_mfma_f32_16x16x32_bf16 v[84:87], v[32:35], v[40:43], v[84:87]
    v_perm_b32 v40, v107, v103, s33
    v_perm_b32 v41, v115, v111, s33
    v_perm_b32 v42, v123, v119, s33
    v_perm_b32 v43, v131, v127, s33
    v_mfma_f32_16x16x32_bf16 v[88:91], v[32:35], v[36:39], v[88:91]
    s_nop 0
    v_mfma_f32_16x16x32_bf16 v[92:95], v[32:35], v[40:43], v[92:95]
    v_mfma_f32_16x16x32_bf16 v[16:19], a[80:83], a[80:83], v[16:19]
    v_mfma_f32_16x16x32_bf16 v[12:15], a[52:55], a[84:87], v[12:15]
    v_mfma_f32_16x16x32_bf16 v[16:19], a[84:87], a[84:87], v[16:19]
    v_mfma_f32_16x16x32_bf16 v[12:15], a[56:59], a[88:91], v[12:15]
    v_mfma_f32_16x16x32_bf16 v[16:19], a[88:91], a[88:91], v[16:19]
    v_mfma_f32_16x16x32_bf16 v[12:15], a[60:63], a[92:95], v[12:15]
    v_mfma_f32_16x16x32_bf16 v[16:19], a[92:95], a[92:95], v[16:19]
    s_nop 7
    s_waitcnt vmcnt(9)
    buffer_load_dwordx4 v[204:207], v2, s[12:15], s16 offen offset:2048 sc1 nt
    buffer_load_dwordx4 v[208:211], v2, s[12:15], s16 offen offset:3072 sc1 nt
    v_mul_f32 v12, s37, v12
    v_mul_f32 v13, s37, v13
    v_mul_f32 v14, s37, v14
    v_mul_f32 v15, s37, v15
    v_cvt_pk_bf16_f32 v24, v12, v13
    v_cvt_pk_bf16_f32 v25, v14, v15
    v_lshlrev_b32 v12, 16, v24
    v_and_b32 v13, 0xffff0000, v24
    v_lshlrev_b32 v14, 16, v25
    v_and_b32 v15, 0xffff0000, v25
    v_mul_f32 v20, v4, v16
    v_mul_f32 v21, v4, v17
    v_mul_f32 v22, v4, v18
    v_mul_f32 v23, v4, v19
    v_cvt_pk_bf16_f32 v24, v20, v21
    v_cvt_pk_bf16_f32 v25, v22, v23
    v_lshlrev_b32 v28, 16, v24
    v_and_b32 v29, 0xffff0000, v24
    v_lshlrev_b32 v30, 16, v25
    v_and_b32 v31, 0xffff0000, v25
    v_sub_f32 v12, v12, v28
    v_sub_f32 v13, v13, v29
    v_sub_f32 v14, v14, v30
    v_sub_f32 v15, v15, v31
    v_cvt_pk_bf16_f32 v24, v12, v13
    v_cvt_pk_bf16_f32 v25, v14, v15
    v_lshlrev_b32 v12, 16, v24
    v_and_b32 v13, 0xffff0000, v24
    v_lshlrev_b32 v14, 16, v25
    v_and_b32 v15, 0xffff0000, v25
    v_mul_f32 v12, s34, v12
    v_mul_f32 v13, s34, v13
    v_mul_f32 v14, s34, v14
    v_mul_f32 v15, s34, v15
    s_waitcnt vmcnt(8)
    ds_read_b64 v[48:49], v7 offset:512
    buffer_load_dwordx4 v[212:215], v3, s[12:15], s16 offen offset:0 sc1 nt
    buffer_load_dwordx4 v[216:219], v3, s[12:15], s16 offen offset:1024 sc1 nt
    v_exp_f32 v12, v12
    v_exp_f32 v13, v13
    v_exp_f32 v14, v14
    v_exp_f32 v15, v15
    s_nop 0
    v_cvt_pk_bf16_f32 v24, v12, v13
    v_cvt_pk_bf16_f32 v25, v14, v15
    v_lshlrev_b32 v12, 16, v24
    v_and_b32 v13, 0xffff0000, v24
    v_lshlrev_b32 v14, 16, v25
    v_and_b32 v15, 0xffff0000, v25
    v_mul_f32 v12, s35, v12
    v_mul_f32 v13, s35, v13
    v_mul_f32 v14, s35, v14
    v_mul_f32 v15, s35, v15
    v_cvt_pk_bf16_f32 v24, v12, v13
    v_cvt_pk_bf16_f32 v25, v14, v15
    v_lshlrev_b32 v12, 16, v24
    v_and_b32 v13, 0xffff0000, v24
    v_lshlrev_b32 v14, 16, v25
    v_and_b32 v15, 0xffff0000, v25
    v_add_f32 v12, s36, v12
    v_add_f32 v13, s36, v13
    v_add_f32 v14, s36, v14
    v_add_f32 v15, s36, v15
    v_cvt_pk_bf16_f32 v24, v12, v13
    v_cvt_pk_bf16_f32 v25, v14, v15
    v_lshlrev_b32 v44, 16, v24
    v_and_b32 v45, 0xffff0000, v24
    v_lshlrev_b32 v46, 16, v25
    v_and_b32 v47, 0xffff0000, v25
    s_waitcnt vmcnt(9)
    buffer_load_dwordx4 v[220:223], v3, s[12:15], s16 offen offset:2048 sc1 nt
    buffer_load_dwordx4 v[224:227], v3, s[12:15], s16 offen offset:3072 sc1 nt
    s_waitcnt lgkmcnt(0)
    v_cndmask_b32 v32, 0, v48, s[28:29]
    v_cndmask_b32 v33, 0, v49, s[28:29]
    v_cndmask_b32 v34, 0, v48, s[30:31]
    v_cndmask_b32 v35, 0, v49, s[30:31]
    s_nop 1
    v_permlane16_swap_b32 v32, v34
    v_permlane16_swap_b32 v33, v35
    s_waitcnt vmcnt(8)
    s_and_b32 s16, s17, 63
    s_lshl_b32 s16, s16, 15
    s_add_u32 s16, s16, s39
    s_xor_b32 s3, s17, s19
    s_and_b32 s3, s3, 1
    s_lshl_b32 s3, s3, 13
    s_add_u32 s16, s16, s3
    s_add_u32 s17, s17, 1
    buffer_load_dwordx4 v[100:103], v2, s[12:15], s16 offen offset:0 sc1 nt
    buffer_load_dwordx4 v[104:107], v2, s[12:15], s16 offen offset:1024 sc1 nt
    v_perm_b32 v36, v136, v132, s32
    v_perm_b32 v37, v144, v140, s32
    v_perm_b32 v38, v152, v148, s32
    v_perm_b32 v39, v160, v156, s32
    v_mfma_f32_16x16x32_bf16 v[96:99], v[32:35], v[8:11], v[96:99]
    v_perm_b32 v40, v136, v132, s33
    v_perm_b32 v41, v144, v140, s33
    v_perm_b32 v42, v152, v148, s33
    v_perm_b32 v43, v160, v156, s33
    v_mfma_f32_16x16x32_bf16 v[64:67], v[32:35], v[36:39], v[64:67]
    v_perm_b32 v36, v137, v133, s32
    v_perm_b32 v37, v145, v141, s32
    v_perm_b32 v38, v153, v149, s32
    v_perm_b32 v39, v161, v157, s32
    v_mfma_f32_16x16x32_bf16 v[68:71], v[32:35], v[40:43], v[68:71]
    v_perm_b32 v40, v137, v133, s33
    v_perm_b32 v41, v145, v141, s33
    v_perm_b32 v42, v153, v149, s33
    v_perm_b32 v43, v161, v157, s33
    v_mfma_f32_16x16x32_bf16 v[72:75], v[32:35], v[36:39], v[72:75]
    v_perm_b32 v36, v138, v134, s32
    v_perm_b32 v37, v146, v142, s32
    v_perm_b32 v38, v154, v150, s32
    v_perm_b32 v39, v162, v158, s32
    v_mfma_f32_16x16x32_bf16 v[76:79], v[32:35], v[40:43], v[76:79]
    v_perm_b32 v40, v138, v134, s33
    v_perm_b32 v41, v146, v142, s33
    v_perm_b32 v42, v154, v150, s33
    v_perm_b32 v43, v162, v158, s33
    v_mfma_f32_16x16x32_bf16 v[80:83], v[32:35], v[36:39], v[80:83]
    v_perm_b32 v36, v139, v135, s32
    v_perm_b32 v37, v147, v143, s32
    v_perm_b32 v38, v155, v151, s32
    v_perm_b32 v39, v163, v159, s32
    v_mfma_f32_16x16x32_bf16 v[84:87], v[32:35], v[40:43], v[84:87]
    v_perm_b32 v40, v139, v135, s33
    v_perm_b32 v41, v147, v143, s33
    v_perm_b32 v42, v155, v151, s33
    v_perm_b32 v43, v163, v159, s33
    v_mfma_f32_16x16x32_bf16 v[88:91], v[32:35], v[36:39], v[88:91]
    s_nop 0
    v_mfma_f32_16x16x32_bf16 v[92:95], v[32:35], v[40:43], v[92:95]
    s_waitcnt vmcnt(9)
    buffer_load_dwordx4 v[108:111], v2, s[12:15], s16 offen offset:2048 sc1 nt
    buffer_load_dwordx4 v[112:115], v2, s[12:15], s16 offen offset:3072 sc1 nt
    s_waitcnt vmcnt(8)
    ds_read_b64 v[48:49], v7 offset:1024
    buffer_load_dwordx4 v[116:119], v3, s[12:15], s16 offen offset:0 sc1 nt
    buffer_load_dwordx4 v[120:123], v3, s[12:15], s16 offen offset:1024 sc1 nt
    s_waitcnt vmcnt(9)
    buffer_load_dwordx4 v[124:127], v3, s[12:15], s16 offen offset:2048 sc1 nt
    buffer_load_dwordx4 v[128:131], v3, s[12:15], s16 offen offset:3072 sc1 nt
    s_waitcnt lgkmcnt(0)
    v_cndmask_b32 v32, 0, v48, s[28:29]
    v_cndmask_b32 v33, 0, v49, s[28:29]
    v_cndmask_b32 v34, 0, v48, s[30:31]
    v_cndmask_b32 v35, 0, v49, s[30:31]
    s_nop 1
    v_permlane16_swap_b32 v32, v34
    v_permlane16_swap_b32 v33, v35
    s_waitcnt vmcnt(8)
    s_and_b32 s16, s17, 63
    s_lshl_b32 s16, s16, 15
    s_add_u32 s16, s16, s39
    s_xor_b32 s3, s17, s19
    s_and_b32 s3, s3, 1
    s_lshl_b32 s3, s3, 13
    s_add_u32 s16, s16, s3
    s_add_u32 s17, s17, 1
    buffer_load_dwordx4 v[132:135], v2, s[12:15], s16 offen offset:0 sc1 nt
    buffer_load_dwordx4 v[136:139], v2, s[12:15], s16 offen offset:1024 sc1 nt
    v_perm_b32 v36, v168, v164, s32
    v_perm_b32 v37, v176, v172, s32
    v_perm_b32 v38, v184, v180, s32
    v_perm_b32 v39, v192, v188, s32
    v_mfma_f32_16x16x32_bf16 v[96:99], v[32:35], v[8:11], v[96:99]
    v_perm_b32 v40, v168, v164, s33
    v_perm_b32 v41, v176, v172, s33
    v_perm_b32 v42, v184, v180, s33
    v_perm_b32 v43, v192, v188, s33
    v_mfma_f32_16x16x32_bf16 v[64:67], v[32:35], v[36:39], v[64:67]
    v_perm_b32 v36, v169, v165, s32
    v_perm_b32 v37, v177, v173, s32
    v_perm_b32 v38, v185, v181, s32
    v_perm_b32 v39, v193, v189, s32
    v_mfma_f32_16x16x32_bf16 v[68:71], v[32:35], v[40:43], v[68:71]
    v_perm_b32 v40, v169, v165, s33
    v_perm_b32 v41, v177, v173, s33
    v_perm_b32 v42, v185, v181, s33
    v_perm_b32 v43, v193, v189, s33
    v_mfma_f32_16x16x32_bf16 v[72:75], v[32:35], v[36:39], v[72:75]
    v_perm_b32 v36, v170, v166, s32
    v_perm_b32 v37, v178, v174, s32
    v_perm_b32 v38, v186, v182, s32
    v_perm_b32 v39, v194, v190, s32
    v_mfma_f32_16x16x32_bf16 v[76:79], v[32:35], v[40:43], v[76:79]
    v_perm_b32 v40, v170, v166, s33
    v_perm_b32 v41, v178, v174, s33
    v_perm_b32 v42, v186, v182, s33
    v_perm_b32 v43, v194, v190, s33
    v_mfma_f32_16x16x32_bf16 v[80:83], v[32:35], v[36:39], v[80:83]
    v_perm_b32 v36, v171, v167, s32
    v_perm_b32 v37, v179, v175, s32
    v_perm_b32 v38, v187, v183, s32
    v_perm_b32 v39, v195, v191, s32
    v_mfma_f32_16x16x32_bf16 v[84:87], v[32:35], v[40:43], v[84:87]
    v_perm_b32 v40, v171, v167, s33
    v_perm_b32 v41, v179, v175, s33
    v_perm_b32 v42, v187, v183, s33
    v_perm_b32 v43, v195, v191, s33
    v_mfma_f32_16x16x32_bf16 v[88:91], v[32:35], v[36:39], v[88:91]
    s_nop 0
    v_mfma_f32_16x16x32_bf16 v[92:95], v[32:35], v[40:43], v[92:95]
    s_waitcnt vmcnt(9)
    buffer_load_dwordx4 v[140:143], v2, s[12:15], s16 offen offset:2048 sc1 nt
    buffer_load_dwordx4 v[144:147], v2, s[12:15], s16 offen offset:3072 sc1 nt
    s_waitcnt vmcnt(8)
    ds_read_b64 v[48:49], v7 offset:1536
    buffer_load_dwordx4 v[148:151], v3, s[12:15], s16 offen offset:0 sc1 nt
    buffer_load_dwordx4 v[152:155], v3, s[12:15], s16 offen offset:1024 sc1 nt
    s_waitcnt vmcnt(9)
    buffer_load_dwordx4 v[156:159], v3, s[12:15], s16 offen offset:2048 sc1 nt
    buffer_load_dwordx4 v[160:163], v3, s[12:15], s16 offen offset:3072 sc1 nt
    s_waitcnt lgkmcnt(0)
    v_cndmask_b32 v32, 0, v48, s[28:29]
    v_cndmask_b32 v33, 0, v49, s[28:29]
    v_cndmask_b32 v34, 0, v48, s[30:31]
    v_cndmask_b32 v35, 0, v49, s[30:31]
    s_nop 1
    v_permlane16_swap_b32 v32, v34
    v_permlane16_swap_b32 v33, v35
    s_waitcnt vmcnt(8)
    s_and_b32 s16, s17, 63
    s_lshl_b32 s16, s16, 15
    s_add_u32 s16, s16, s39
    s_xor_b32 s3, s17, s19
    s_and_b32 s3, s3, 1
    s_lshl_b32 s3, s3, 13
    s_add_u32 s16, s16, s3
    s_add_u32 s17, s17, 1
    buffer_load_dwordx4 v[164:167], v2, s[12:15], s16 offen offset:0 sc1 nt
    buffer_load_dwordx4 v[168:171], v2, s[12:15], s16 offen offset:1024 sc1 nt
    v_perm_b32 v36, v200, v196, s32
    v_perm_b32 v37, v208, v204, s32
    v_perm_b32 v38, v216, v212, s32
    v_perm_b32 v39, v224, v220, s32
    v_mfma_f32_16x16x32_bf16 v[96:99], v[32:35], v[8:11], v[96:99]
    v_perm_b32 v40, v200, v196, s33
    v_perm_b32 v41, v208, v204, s33
    v_perm_b32 v42, v216, v212, s33
    v_perm_b32 v43, v224, v220, s33
    v_mfma_f32_16x16x32_bf16 v[64:67], v[32:35], v[36:39], v[64:67]
    v_perm_b32 v36, v201, v197, s32
    v_perm_b32 v37, v209, v205, s32
    v_perm_b32 v38, v217, v213, s32
    v_perm_b32 v39, v225, v221, s32
    v_mfma_f32_16x16x32_bf16 v[68:71], v[32:35], v[40:43], v[68:71]
    v_perm_b32 v40, v201, v197, s33
    v_perm_b32 v41, v209, v205, s33
    v_perm_b32 v42, v217, v213, s33
    v_perm_b32 v43, v225, v221, s33
    v_mfma_f32_16x16x32_bf16 v[72:75], v[32:35], v[36:39], v[72:75]
    v_perm_b32 v36, v202, v198, s32
    v_perm_b32 v37, v210, v206, s32
    v_perm_b32 v38, v218, v214, s32
    v_perm_b32 v39, v226, v222, s32
    v_mfma_f32_16x16x32_bf16 v[76:79], v[32:35], v[40:43], v[76:79]
    v_perm_b32 v40, v202, v198, s33
    v_perm_b32 v41, v210, v206, s33
    v_perm_b32 v42, v218, v214, s33
    v_perm_b32 v43, v226, v222, s33
    v_mfma_f32_16x16x32_bf16 v[80:83], v[32:35], v[36:39], v[80:83]
    v_perm_b32 v36, v203, v199, s32
    v_perm_b32 v37, v211, v207, s32
    v_perm_b32 v38, v219, v215, s32
    v_perm_b32 v39, v227, v223, s32
    v_mfma_f32_16x16x32_bf16 v[84:87], v[32:35], v[40:43], v[84:87]
    v_perm_b32 v40, v203, v199, s33
    v_perm_b32 v41, v211, v207, s33
    v_perm_b32 v42, v219, v215, s33
    v_perm_b32 v43, v227, v223, s33
    v_mfma_f32_16x16x32_bf16 v[88:91], v[32:35], v[36:39], v[88:91]
    s_nop 0
    v_mfma_f32_16x16x32_bf16 v[92:95], v[32:35], v[40:43], v[92:95]
    s_waitcnt vmcnt(9)
    buffer_load_dwordx4 v[172:175], v2, s[12:15], s16 offen offset:2048 sc1 nt
    buffer_load_dwordx4 v[176:179], v2, s[12:15], s16 offen offset:3072 sc1 nt
    v_add_u32 v7, 2048, v7
    s_mov_b32 s18, 10
L_vloop_standalone__linear_kernel_rfa__decode_kernel:
    s_waitcnt vmcnt(8)
    ds_read_b64 v[48:49], v7 offset:0
    buffer_load_dwordx4 v[180:183], v3, s[12:15], s16 offen offset:0 sc1 nt
    buffer_load_dwordx4 v[184:187], v3, s[12:15], s16 offen offset:1024 sc1 nt
    s_waitcnt vmcnt(9)
    buffer_load_dwordx4 v[188:191], v3, s[12:15], s16 offen offset:2048 sc1 nt
    buffer_load_dwordx4 v[192:195], v3, s[12:15], s16 offen offset:3072 sc1 nt
    s_waitcnt lgkmcnt(0)
    v_cndmask_b32 v32, 0, v48, s[28:29]
    v_cndmask_b32 v33, 0, v49, s[28:29]
    v_cndmask_b32 v34, 0, v48, s[30:31]
    v_cndmask_b32 v35, 0, v49, s[30:31]
    s_nop 1
    v_permlane16_swap_b32 v32, v34
    v_permlane16_swap_b32 v33, v35
    s_waitcnt vmcnt(8)
    s_and_b32 s16, s17, 63
    s_lshl_b32 s16, s16, 15
    s_add_u32 s16, s16, s39
    s_xor_b32 s3, s17, s19
    s_and_b32 s3, s3, 1
    s_lshl_b32 s3, s3, 13
    s_add_u32 s16, s16, s3
    s_add_u32 s17, s17, 1
    buffer_load_dwordx4 v[196:199], v2, s[12:15], s16 offen offset:0 sc1 nt
    buffer_load_dwordx4 v[200:203], v2, s[12:15], s16 offen offset:1024 sc1 nt
    v_perm_b32 v36, v104, v100, s32
    v_perm_b32 v37, v112, v108, s32
    v_perm_b32 v38, v120, v116, s32
    v_perm_b32 v39, v128, v124, s32
    v_mfma_f32_16x16x32_bf16 v[96:99], v[32:35], v[8:11], v[96:99]
    v_perm_b32 v40, v104, v100, s33
    v_perm_b32 v41, v112, v108, s33
    v_perm_b32 v42, v120, v116, s33
    v_perm_b32 v43, v128, v124, s33
    v_mfma_f32_16x16x32_bf16 v[64:67], v[32:35], v[36:39], v[64:67]
    v_perm_b32 v36, v105, v101, s32
    v_perm_b32 v37, v113, v109, s32
    v_perm_b32 v38, v121, v117, s32
    v_perm_b32 v39, v129, v125, s32
    v_mfma_f32_16x16x32_bf16 v[68:71], v[32:35], v[40:43], v[68:71]
    v_perm_b32 v40, v105, v101, s33
    v_perm_b32 v41, v113, v109, s33
    v_perm_b32 v42, v121, v117, s33
    v_perm_b32 v43, v129, v125, s33
    v_mfma_f32_16x16x32_bf16 v[72:75], v[32:35], v[36:39], v[72:75]
    v_perm_b32 v36, v106, v102, s32
    v_perm_b32 v37, v114, v110, s32
    v_perm_b32 v38, v122, v118, s32
    v_perm_b32 v39, v130, v126, s32
    v_mfma_f32_16x16x32_bf16 v[76:79], v[32:35], v[40:43], v[76:79]
    v_perm_b32 v40, v106, v102, s33
    v_perm_b32 v41, v114, v110, s33
    v_perm_b32 v42, v122, v118, s33
    v_perm_b32 v43, v130, v126, s33
    v_mfma_f32_16x16x32_bf16 v[80:83], v[32:35], v[36:39], v[80:83]
    v_perm_b32 v36, v107, v103, s32
    v_perm_b32 v37, v115, v111, s32
    v_perm_b32 v38, v123, v119, s32
    v_perm_b32 v39, v131, v127, s32
    v_mfma_f32_16x16x32_bf16 v[84:87], v[32:35], v[40:43], v[84:87]
    v_perm_b32 v40, v107, v103, s33
    v_perm_b32 v41, v115, v111, s33
    v_perm_b32 v42, v123, v119, s33
    v_perm_b32 v43, v131, v127, s33
    v_mfma_f32_16x16x32_bf16 v[88:91], v[32:35], v[36:39], v[88:91]
    s_nop 0
    v_mfma_f32_16x16x32_bf16 v[92:95], v[32:35], v[40:43], v[92:95]
    s_waitcnt vmcnt(9)
    buffer_load_dwordx4 v[204:207], v2, s[12:15], s16 offen offset:2048 sc1 nt
    buffer_load_dwordx4 v[208:211], v2, s[12:15], s16 offen offset:3072 sc1 nt
    s_waitcnt vmcnt(8)
    ds_read_b64 v[48:49], v7 offset:512
    buffer_load_dwordx4 v[212:215], v3, s[12:15], s16 offen offset:0 sc1 nt
    buffer_load_dwordx4 v[216:219], v3, s[12:15], s16 offen offset:1024 sc1 nt
    s_waitcnt vmcnt(9)
    buffer_load_dwordx4 v[220:223], v3, s[12:15], s16 offen offset:2048 sc1 nt
    buffer_load_dwordx4 v[224:227], v3, s[12:15], s16 offen offset:3072 sc1 nt
    s_waitcnt lgkmcnt(0)
    v_cndmask_b32 v32, 0, v48, s[28:29]
    v_cndmask_b32 v33, 0, v49, s[28:29]
    v_cndmask_b32 v34, 0, v48, s[30:31]
    v_cndmask_b32 v35, 0, v49, s[30:31]
    s_nop 1
    v_permlane16_swap_b32 v32, v34
    v_permlane16_swap_b32 v33, v35
    s_waitcnt vmcnt(8)
    s_and_b32 s16, s17, 63
    s_lshl_b32 s16, s16, 15
    s_add_u32 s16, s16, s39
    s_xor_b32 s3, s17, s19
    s_and_b32 s3, s3, 1
    s_lshl_b32 s3, s3, 13
    s_add_u32 s16, s16, s3
    s_add_u32 s17, s17, 1
    buffer_load_dwordx4 v[100:103], v2, s[12:15], s16 offen offset:0 sc1 nt
    buffer_load_dwordx4 v[104:107], v2, s[12:15], s16 offen offset:1024 sc1 nt
    v_perm_b32 v36, v136, v132, s32
    v_perm_b32 v37, v144, v140, s32
    v_perm_b32 v38, v152, v148, s32
    v_perm_b32 v39, v160, v156, s32
    v_mfma_f32_16x16x32_bf16 v[96:99], v[32:35], v[8:11], v[96:99]
    v_perm_b32 v40, v136, v132, s33
    v_perm_b32 v41, v144, v140, s33
    v_perm_b32 v42, v152, v148, s33
    v_perm_b32 v43, v160, v156, s33
    v_mfma_f32_16x16x32_bf16 v[64:67], v[32:35], v[36:39], v[64:67]
    v_perm_b32 v36, v137, v133, s32
    v_perm_b32 v37, v145, v141, s32
    v_perm_b32 v38, v153, v149, s32
    v_perm_b32 v39, v161, v157, s32
    v_mfma_f32_16x16x32_bf16 v[68:71], v[32:35], v[40:43], v[68:71]
    v_perm_b32 v40, v137, v133, s33
    v_perm_b32 v41, v145, v141, s33
    v_perm_b32 v42, v153, v149, s33
    v_perm_b32 v43, v161, v157, s33
    v_mfma_f32_16x16x32_bf16 v[72:75], v[32:35], v[36:39], v[72:75]
    v_perm_b32 v36, v138, v134, s32
    v_perm_b32 v37, v146, v142, s32
    v_perm_b32 v38, v154, v150, s32
    v_perm_b32 v39, v162, v158, s32
    v_mfma_f32_16x16x32_bf16 v[76:79], v[32:35], v[40:43], v[76:79]
    v_perm_b32 v40, v138, v134, s33
    v_perm_b32 v41, v146, v142, s33
    v_perm_b32 v42, v154, v150, s33
    v_perm_b32 v43, v162, v158, s33
    v_mfma_f32_16x16x32_bf16 v[80:83], v[32:35], v[36:39], v[80:83]
    v_perm_b32 v36, v139, v135, s32
    v_perm_b32 v37, v147, v143, s32
    v_perm_b32 v38, v155, v151, s32
    v_perm_b32 v39, v163, v159, s32
    v_mfma_f32_16x16x32_bf16 v[84:87], v[32:35], v[40:43], v[84:87]
    v_perm_b32 v40, v139, v135, s33
    v_perm_b32 v41, v147, v143, s33
    v_perm_b32 v42, v155, v151, s33
    v_perm_b32 v43, v163, v159, s33
    v_mfma_f32_16x16x32_bf16 v[88:91], v[32:35], v[36:39], v[88:91]
    s_nop 0
    v_mfma_f32_16x16x32_bf16 v[92:95], v[32:35], v[40:43], v[92:95]
    s_waitcnt vmcnt(9)
    buffer_load_dwordx4 v[108:111], v2, s[12:15], s16 offen offset:2048 sc1 nt
    buffer_load_dwordx4 v[112:115], v2, s[12:15], s16 offen offset:3072 sc1 nt
    s_waitcnt vmcnt(8)
    ds_read_b64 v[48:49], v7 offset:1024
    buffer_load_dwordx4 v[116:119], v3, s[12:15], s16 offen offset:0 sc1 nt
    buffer_load_dwordx4 v[120:123], v3, s[12:15], s16 offen offset:1024 sc1 nt
    s_waitcnt vmcnt(9)
    buffer_load_dwordx4 v[124:127], v3, s[12:15], s16 offen offset:2048 sc1 nt
    buffer_load_dwordx4 v[128:131], v3, s[12:15], s16 offen offset:3072 sc1 nt
    s_waitcnt lgkmcnt(0)
    v_cndmask_b32 v32, 0, v48, s[28:29]
    v_cndmask_b32 v33, 0, v49, s[28:29]
    v_cndmask_b32 v34, 0, v48, s[30:31]
    v_cndmask_b32 v35, 0, v49, s[30:31]
    s_nop 1
    v_permlane16_swap_b32 v32, v34
    v_permlane16_swap_b32 v33, v35
    s_waitcnt vmcnt(8)
    s_and_b32 s16, s17, 63
    s_lshl_b32 s16, s16, 15
    s_add_u32 s16, s16, s39
    s_xor_b32 s3, s17, s19
    s_and_b32 s3, s3, 1
    s_lshl_b32 s3, s3, 13
    s_add_u32 s16, s16, s3
    s_add_u32 s17, s17, 1
    buffer_load_dwordx4 v[132:135], v2, s[12:15], s16 offen offset:0 sc1 nt
    buffer_load_dwordx4 v[136:139], v2, s[12:15], s16 offen offset:1024 sc1 nt
    v_perm_b32 v36, v168, v164, s32
    v_perm_b32 v37, v176, v172, s32
    v_perm_b32 v38, v184, v180, s32
    v_perm_b32 v39, v192, v188, s32
    v_mfma_f32_16x16x32_bf16 v[96:99], v[32:35], v[8:11], v[96:99]
    v_perm_b32 v40, v168, v164, s33
    v_perm_b32 v41, v176, v172, s33
    v_perm_b32 v42, v184, v180, s33
    v_perm_b32 v43, v192, v188, s33
    v_mfma_f32_16x16x32_bf16 v[64:67], v[32:35], v[36:39], v[64:67]
    v_perm_b32 v36, v169, v165, s32
    v_perm_b32 v37, v177, v173, s32
    v_perm_b32 v38, v185, v181, s32
    v_perm_b32 v39, v193, v189, s32
    v_mfma_f32_16x16x32_bf16 v[68:71], v[32:35], v[40:43], v[68:71]
    v_perm_b32 v40, v169, v165, s33
    v_perm_b32 v41, v177, v173, s33
    v_perm_b32 v42, v185, v181, s33
    v_perm_b32 v43, v193, v189, s33
    v_mfma_f32_16x16x32_bf16 v[72:75], v[32:35], v[36:39], v[72:75]
    v_perm_b32 v36, v170, v166, s32
    v_perm_b32 v37, v178, v174, s32
    v_perm_b32 v38, v186, v182, s32
    v_perm_b32 v39, v194, v190, s32
    v_mfma_f32_16x16x32_bf16 v[76:79], v[32:35], v[40:43], v[76:79]
    v_perm_b32 v40, v170, v166, s33
    v_perm_b32 v41, v178, v174, s33
    v_perm_b32 v42, v186, v182, s33
    v_perm_b32 v43, v194, v190, s33
    v_mfma_f32_16x16x32_bf16 v[80:83], v[32:35], v[36:39], v[80:83]
    v_perm_b32 v36, v171, v167, s32
    v_perm_b32 v37, v179, v175, s32
    v_perm_b32 v38, v187, v183, s32
    v_perm_b32 v39, v195, v191, s32
    v_mfma_f32_16x16x32_bf16 v[84:87], v[32:35], v[40:43], v[84:87]
    v_perm_b32 v40, v171, v167, s33
    v_perm_b32 v41, v179, v175, s33
    v_perm_b32 v42, v187, v183, s33
    v_perm_b32 v43, v195, v191, s33
    v_mfma_f32_16x16x32_bf16 v[88:91], v[32:35], v[36:39], v[88:91]
    s_nop 0
    v_mfma_f32_16x16x32_bf16 v[92:95], v[32:35], v[40:43], v[92:95]
    s_waitcnt vmcnt(9)
    buffer_load_dwordx4 v[140:143], v2, s[12:15], s16 offen offset:2048 sc1 nt
    buffer_load_dwordx4 v[144:147], v2, s[12:15], s16 offen offset:3072 sc1 nt
    s_waitcnt vmcnt(8)
    ds_read_b64 v[48:49], v7 offset:1536
    buffer_load_dwordx4 v[148:151], v3, s[12:15], s16 offen offset:0 sc1 nt
    buffer_load_dwordx4 v[152:155], v3, s[12:15], s16 offen offset:1024 sc1 nt
    s_waitcnt vmcnt(9)
    buffer_load_dwordx4 v[156:159], v3, s[12:15], s16 offen offset:2048 sc1 nt
    buffer_load_dwordx4 v[160:163], v3, s[12:15], s16 offen offset:3072 sc1 nt
    s_waitcnt lgkmcnt(0)
    v_cndmask_b32 v32, 0, v48, s[28:29]
    v_cndmask_b32 v33, 0, v49, s[28:29]
    v_cndmask_b32 v34, 0, v48, s[30:31]
    v_cndmask_b32 v35, 0, v49, s[30:31]
    s_nop 1
    v_permlane16_swap_b32 v32, v34
    v_permlane16_swap_b32 v33, v35
    s_waitcnt vmcnt(8)
    s_and_b32 s16, s17, 63
    s_lshl_b32 s16, s16, 15
    s_add_u32 s16, s16, s39
    s_xor_b32 s3, s17, s19
    s_and_b32 s3, s3, 1
    s_lshl_b32 s3, s3, 13
    s_add_u32 s16, s16, s3
    s_add_u32 s17, s17, 1
    buffer_load_dwordx4 v[164:167], v2, s[12:15], s16 offen offset:0 sc1 nt
    buffer_load_dwordx4 v[168:171], v2, s[12:15], s16 offen offset:1024 sc1 nt
    v_perm_b32 v36, v200, v196, s32
    v_perm_b32 v37, v208, v204, s32
    v_perm_b32 v38, v216, v212, s32
    v_perm_b32 v39, v224, v220, s32
    v_mfma_f32_16x16x32_bf16 v[96:99], v[32:35], v[8:11], v[96:99]
    v_perm_b32 v40, v200, v196, s33
    v_perm_b32 v41, v208, v204, s33
    v_perm_b32 v42, v216, v212, s33
    v_perm_b32 v43, v224, v220, s33
    v_mfma_f32_16x16x32_bf16 v[64:67], v[32:35], v[36:39], v[64:67]
    v_perm_b32 v36, v201, v197, s32
    v_perm_b32 v37, v209, v205, s32
    v_perm_b32 v38, v217, v213, s32
    v_perm_b32 v39, v225, v221, s32
    v_mfma_f32_16x16x32_bf16 v[68:71], v[32:35], v[40:43], v[68:71]
    v_perm_b32 v40, v201, v197, s33
    v_perm_b32 v41, v209, v205, s33
    v_perm_b32 v42, v217, v213, s33
    v_perm_b32 v43, v225, v221, s33
    v_mfma_f32_16x16x32_bf16 v[72:75], v[32:35], v[36:39], v[72:75]
    v_perm_b32 v36, v202, v198, s32
    v_perm_b32 v37, v210, v206, s32
    v_perm_b32 v38, v218, v214, s32
    v_perm_b32 v39, v226, v222, s32
    v_mfma_f32_16x16x32_bf16 v[76:79], v[32:35], v[40:43], v[76:79]
    v_perm_b32 v40, v202, v198, s33
    v_perm_b32 v41, v210, v206, s33
    v_perm_b32 v42, v218, v214, s33
    v_perm_b32 v43, v226, v222, s33
    v_mfma_f32_16x16x32_bf16 v[80:83], v[32:35], v[36:39], v[80:83]
    v_perm_b32 v36, v203, v199, s32
    v_perm_b32 v37, v211, v207, s32
    v_perm_b32 v38, v219, v215, s32
    v_perm_b32 v39, v227, v223, s32
    v_mfma_f32_16x16x32_bf16 v[84:87], v[32:35], v[40:43], v[84:87]
    v_perm_b32 v40, v203, v199, s33
    v_perm_b32 v41, v211, v207, s33
    v_perm_b32 v42, v219, v215, s33
    v_perm_b32 v43, v227, v223, s33
    v_mfma_f32_16x16x32_bf16 v[88:91], v[32:35], v[36:39], v[88:91]
    s_nop 0
    v_mfma_f32_16x16x32_bf16 v[92:95], v[32:35], v[40:43], v[92:95]
    s_waitcnt vmcnt(9)
    buffer_load_dwordx4 v[172:175], v2, s[12:15], s16 offen offset:2048 sc1 nt
    buffer_load_dwordx4 v[176:179], v2, s[12:15], s16 offen offset:3072 sc1 nt
    v_add_u32 v7, 2048, v7
    s_sub_u32 s18, s18, 1
    s_cmp_lg_u32 s18, 0
    s_cbranch_scc1 L_vloop_standalone__linear_kernel_rfa__decode_kernel
    s_mov_b32 s18, 4
L_vloop2_standalone__linear_kernel_rfa__decode_kernel:
    s_waitcnt vmcnt(16)
    ds_read_b64 v[48:49], v7 offset:0
    buffer_load_dwordx4 v[180:183], v3, s[12:15], s16 offen offset:0 sc1 nt
    buffer_load_dwordx4 v[184:187], v3, s[12:15], s16 offen offset:1024 sc1 nt
    s_waitcnt vmcnt(16)
    buffer_load_dwordx4 v[188:191], v3, s[12:15], s16 offen offset:2048 sc1 nt
    buffer_load_dwordx4 v[192:195], v3, s[12:15], s16 offen offset:3072 sc1 nt
    s_waitcnt lgkmcnt(0)
    v_cndmask_b32 v32, 0, v48, s[28:29]
    v_cndmask_b32 v33, 0, v49, s[28:29]
    v_cndmask_b32 v34, 0, v48, s[30:31]
    v_cndmask_b32 v35, 0, v49, s[30:31]
    s_nop 1
    v_permlane16_swap_b32 v32, v34
    v_permlane16_swap_b32 v33, v35
    s_waitcnt vmcnt(16)
    s_and_b32 s16, s17, 63
    s_lshl_b32 s16, s16, 15
    s_add_u32 s16, s16, s39
    s_xor_b32 s3, s17, s19
    s_and_b32 s3, s3, 1
    s_lshl_b32 s3, s3, 13
    s_add_u32 s16, s16, s3
    s_add_u32 s17, s17, 1
    buffer_load_dwordx4 v[196:199], v2, s[12:15], s16 offen offset:0 sc1 nt
    buffer_load_dwordx4 v[200:203], v2, s[12:15], s16 offen offset:1024 sc1 nt
    v_perm_b32 v36, v104, v100, s32
    v_perm_b32 v37, v112, v108, s32
    v_perm_b32 v38, v120, v116, s32
    v_perm_b32 v39, v128, v124, s32
    v_mfma_f32_16x16x32_bf16 v[96:99], v[32:35], v[8:11], v[96:99]
    v_perm_b32 v40, v104, v100, s33
    v_perm_b32 v41, v112, v108, s33
    v_perm_b32 v42, v120, v116, s33
    v_perm_b32 v43, v128, v124, s33
    v_mfma_f32_16x16x32_bf16 v[64:67], v[32:35], v[36:39], v[64:67]
    v_perm_b32 v36, v105, v101, s32
    v_perm_b32 v37, v113, v109, s32
    v_perm_b32 v38, v121, v117, s32
    v_perm_b32 v39, v129, v125, s32
    v_mfma_f32_16x16x32_bf16 v[68:71], v[32:35], v[40:43], v[68:71]
    v_perm_b32 v40, v105, v101, s33
    v_perm_b32 v41, v113, v109, s33
    v_perm_b32 v42, v121, v117, s33
    v_perm_b32 v43, v129, v125, s33
    v_mfma_f32_16x16x32_bf16 v[72:75], v[32:35], v[36:39], v[72:75]
    v_perm_b32 v36, v106, v102, s32
    v_perm_b32 v37, v114, v110, s32
    v_perm_b32 v38, v122, v118, s32
    v_perm_b32 v39, v130, v126, s32
    v_mfma_f32_16x16x32_bf16 v[76:79], v[32:35], v[40:43], v[76:79]
    v_perm_b32 v40, v106, v102, s33
    v_perm_b32 v41, v114, v110, s33
    v_perm_b32 v42, v122, v118, s33
    v_perm_b32 v43, v130, v126, s33
    v_mfma_f32_16x16x32_bf16 v[80:83], v[32:35], v[36:39], v[80:83]
    v_perm_b32 v36, v107, v103, s32
    v_perm_b32 v37, v115, v111, s32
    v_perm_b32 v38, v123, v119, s32
    v_perm_b32 v39, v131, v127, s32
    v_mfma_f32_16x16x32_bf16 v[84:87], v[32:35], v[40:43], v[84:87]
    v_perm_b32 v40, v107, v103, s33
    v_perm_b32 v41, v115, v111, s33
    v_perm_b32 v42, v123, v119, s33
    v_perm_b32 v43, v131, v127, s33
    v_mfma_f32_16x16x32_bf16 v[88:91], v[32:35], v[36:39], v[88:91]
    s_nop 0
    v_mfma_f32_16x16x32_bf16 v[92:95], v[32:35], v[40:43], v[92:95]
    s_waitcnt vmcnt(16)
    buffer_load_dwordx4 v[204:207], v2, s[12:15], s16 offen offset:2048 sc1 nt
    buffer_load_dwordx4 v[208:211], v2, s[12:15], s16 offen offset:3072 sc1 nt
    s_waitcnt vmcnt(16)
    ds_read_b64 v[48:49], v7 offset:512
    buffer_load_dwordx4 v[212:215], v3, s[12:15], s16 offen offset:0 sc1 nt
    buffer_load_dwordx4 v[216:219], v3, s[12:15], s16 offen offset:1024 sc1 nt
    s_waitcnt vmcnt(16)
    buffer_load_dwordx4 v[220:223], v3, s[12:15], s16 offen offset:2048 sc1 nt
    buffer_load_dwordx4 v[224:227], v3, s[12:15], s16 offen offset:3072 sc1 nt
    s_waitcnt lgkmcnt(0)
    v_cndmask_b32 v32, 0, v48, s[28:29]
    v_cndmask_b32 v33, 0, v49, s[28:29]
    v_cndmask_b32 v34, 0, v48, s[30:31]
    v_cndmask_b32 v35, 0, v49, s[30:31]
    s_nop 1
    v_permlane16_swap_b32 v32, v34
    v_permlane16_swap_b32 v33, v35
    s_waitcnt vmcnt(16)
    s_and_b32 s16, s17, 63
    s_lshl_b32 s16, s16, 15
    s_add_u32 s16, s16, s39
    s_xor_b32 s3, s17, s19
    s_and_b32 s3, s3, 1
    s_lshl_b32 s3, s3, 13
    s_add_u32 s16, s16, s3
    s_add_u32 s17, s17, 1
    buffer_load_dwordx4 v[100:103], v2, s[12:15], s16 offen offset:0 sc1 nt
    buffer_load_dwordx4 v[104:107], v2, s[12:15], s16 offen offset:1024 sc1 nt
    v_perm_b32 v36, v136, v132, s32
    v_perm_b32 v37, v144, v140, s32
    v_perm_b32 v38, v152, v148, s32
    v_perm_b32 v39, v160, v156, s32
    v_mfma_f32_16x16x32_bf16 v[96:99], v[32:35], v[8:11], v[96:99]
    v_perm_b32 v40, v136, v132, s33
    v_perm_b32 v41, v144, v140, s33
    v_perm_b32 v42, v152, v148, s33
    v_perm_b32 v43, v160, v156, s33
    v_mfma_f32_16x16x32_bf16 v[64:67], v[32:35], v[36:39], v[64:67]
    v_perm_b32 v36, v137, v133, s32
    v_perm_b32 v37, v145, v141, s32
    v_perm_b32 v38, v153, v149, s32
    v_perm_b32 v39, v161, v157, s32
    v_mfma_f32_16x16x32_bf16 v[68:71], v[32:35], v[40:43], v[68:71]
    v_perm_b32 v40, v137, v133, s33
    v_perm_b32 v41, v145, v141, s33
    v_perm_b32 v42, v153, v149, s33
    v_perm_b32 v43, v161, v157, s33
    v_mfma_f32_16x16x32_bf16 v[72:75], v[32:35], v[36:39], v[72:75]
    v_perm_b32 v36, v138, v134, s32
    v_perm_b32 v37, v146, v142, s32
    v_perm_b32 v38, v154, v150, s32
    v_perm_b32 v39, v162, v158, s32
    v_mfma_f32_16x16x32_bf16 v[76:79], v[32:35], v[40:43], v[76:79]
    v_perm_b32 v40, v138, v134, s33
    v_perm_b32 v41, v146, v142, s33
    v_perm_b32 v42, v154, v150, s33
    v_perm_b32 v43, v162, v158, s33
    v_mfma_f32_16x16x32_bf16 v[80:83], v[32:35], v[36:39], v[80:83]
    v_perm_b32 v36, v139, v135, s32
    v_perm_b32 v37, v147, v143, s32
    v_perm_b32 v38, v155, v151, s32
    v_perm_b32 v39, v163, v159, s32
    v_mfma_f32_16x16x32_bf16 v[84:87], v[32:35], v[40:43], v[84:87]
    v_perm_b32 v40, v139, v135, s33
    v_perm_b32 v41, v147, v143, s33
    v_perm_b32 v42, v155, v151, s33
    v_perm_b32 v43, v163, v159, s33
    v_mfma_f32_16x16x32_bf16 v[88:91], v[32:35], v[36:39], v[88:91]
    s_nop 0
    v_mfma_f32_16x16x32_bf16 v[92:95], v[32:35], v[40:43], v[92:95]
    s_waitcnt vmcnt(16)
    buffer_load_dwordx4 v[108:111], v2, s[12:15], s16 offen offset:2048 sc1 nt
    buffer_load_dwordx4 v[112:115], v2, s[12:15], s16 offen offset:3072 sc1 nt
    s_waitcnt vmcnt(16)
    ds_read_b64 v[48:49], v7 offset:1024
    buffer_load_dwordx4 v[116:119], v3, s[12:15], s16 offen offset:0 sc1 nt
    buffer_load_dwordx4 v[120:123], v3, s[12:15], s16 offen offset:1024 sc1 nt
    s_waitcnt vmcnt(16)
    buffer_load_dwordx4 v[124:127], v3, s[12:15], s16 offen offset:2048 sc1 nt
    buffer_load_dwordx4 v[128:131], v3, s[12:15], s16 offen offset:3072 sc1 nt
    s_waitcnt lgkmcnt(0)
    v_cndmask_b32 v32, 0, v48, s[28:29]
    v_cndmask_b32 v33, 0, v49, s[28:29]
    v_cndmask_b32 v34, 0, v48, s[30:31]
    v_cndmask_b32 v35, 0, v49, s[30:31]
    s_nop 1
    v_permlane16_swap_b32 v32, v34
    v_permlane16_swap_b32 v33, v35
    s_waitcnt vmcnt(16)
    s_and_b32 s16, s17, 63
    s_lshl_b32 s16, s16, 15
    s_add_u32 s16, s16, s39
    s_xor_b32 s3, s17, s19
    s_and_b32 s3, s3, 1
    s_lshl_b32 s3, s3, 13
    s_add_u32 s16, s16, s3
    s_add_u32 s17, s17, 1
    buffer_load_dwordx4 v[132:135], v2, s[12:15], s16 offen offset:0 sc1 nt
    buffer_load_dwordx4 v[136:139], v2, s[12:15], s16 offen offset:1024 sc1 nt
    v_perm_b32 v36, v168, v164, s32
    v_perm_b32 v37, v176, v172, s32
    v_perm_b32 v38, v184, v180, s32
    v_perm_b32 v39, v192, v188, s32
    v_mfma_f32_16x16x32_bf16 v[96:99], v[32:35], v[8:11], v[96:99]
    v_perm_b32 v40, v168, v164, s33
    v_perm_b32 v41, v176, v172, s33
    v_perm_b32 v42, v184, v180, s33
    v_perm_b32 v43, v192, v188, s33
    v_mfma_f32_16x16x32_bf16 v[64:67], v[32:35], v[36:39], v[64:67]
    v_perm_b32 v36, v169, v165, s32
    v_perm_b32 v37, v177, v173, s32
    v_perm_b32 v38, v185, v181, s32
    v_perm_b32 v39, v193, v189, s32
    v_mfma_f32_16x16x32_bf16 v[68:71], v[32:35], v[40:43], v[68:71]
    v_perm_b32 v40, v169, v165, s33
    v_perm_b32 v41, v177, v173, s33
    v_perm_b32 v42, v185, v181, s33
    v_perm_b32 v43, v193, v189, s33
    v_mfma_f32_16x16x32_bf16 v[72:75], v[32:35], v[36:39], v[72:75]
    v_perm_b32 v36, v170, v166, s32
    v_perm_b32 v37, v178, v174, s32
    v_perm_b32 v38, v186, v182, s32
    v_perm_b32 v39, v194, v190, s32
    v_mfma_f32_16x16x32_bf16 v[76:79], v[32:35], v[40:43], v[76:79]
    v_perm_b32 v40, v170, v166, s33
    v_perm_b32 v41, v178, v174, s33
    v_perm_b32 v42, v186, v182, s33
    v_perm_b32 v43, v194, v190, s33
    v_mfma_f32_16x16x32_bf16 v[80:83], v[32:35], v[36:39], v[80:83]
    v_perm_b32 v36, v171, v167, s32
    v_perm_b32 v37, v179, v175, s32
    v_perm_b32 v38, v187, v183, s32
    v_perm_b32 v39, v195, v191, s32
    v_mfma_f32_16x16x32_bf16 v[84:87], v[32:35], v[40:43], v[84:87]
    v_perm_b32 v40, v171, v167, s33
    v_perm_b32 v41, v179, v175, s33
    v_perm_b32 v42, v187, v183, s33
    v_perm_b32 v43, v195, v191, s33
    v_mfma_f32_16x16x32_bf16 v[88:91], v[32:35], v[36:39], v[88:91]
    s_nop 0
    v_mfma_f32_16x16x32_bf16 v[92:95], v[32:35], v[40:43], v[92:95]
    s_waitcnt vmcnt(16)
    buffer_load_dwordx4 v[140:143], v2, s[12:15], s16 offen offset:2048 sc1 nt
    buffer_load_dwordx4 v[144:147], v2, s[12:15], s16 offen offset:3072 sc1 nt
    s_waitcnt vmcnt(16)
    ds_read_b64 v[48:49], v7 offset:1536
    buffer_load_dwordx4 v[148:151], v3, s[12:15], s16 offen offset:0 sc1 nt
    buffer_load_dwordx4 v[152:155], v3, s[12:15], s16 offen offset:1024 sc1 nt
    s_waitcnt vmcnt(16)
    buffer_load_dwordx4 v[156:159], v3, s[12:15], s16 offen offset:2048 sc1 nt
    buffer_load_dwordx4 v[160:163], v3, s[12:15], s16 offen offset:3072 sc1 nt
    s_waitcnt lgkmcnt(0)
    v_cndmask_b32 v32, 0, v48, s[28:29]
    v_cndmask_b32 v33, 0, v49, s[28:29]
    v_cndmask_b32 v34, 0, v48, s[30:31]
    v_cndmask_b32 v35, 0, v49, s[30:31]
    s_nop 1
    v_permlane16_swap_b32 v32, v34
    v_permlane16_swap_b32 v33, v35
    s_waitcnt vmcnt(16)
    s_and_b32 s16, s17, 63
    s_lshl_b32 s16, s16, 15
    s_add_u32 s16, s16, s39
    s_xor_b32 s3, s17, s19
    s_and_b32 s3, s3, 1
    s_lshl_b32 s3, s3, 13
    s_add_u32 s16, s16, s3
    s_add_u32 s17, s17, 1
    buffer_load_dwordx4 v[164:167], v2, s[12:15], s16 offen offset:0 sc1 nt
    buffer_load_dwordx4 v[168:171], v2, s[12:15], s16 offen offset:1024 sc1 nt
    v_perm_b32 v36, v200, v196, s32
    v_perm_b32 v37, v208, v204, s32
    v_perm_b32 v38, v216, v212, s32
    v_perm_b32 v39, v224, v220, s32
    v_mfma_f32_16x16x32_bf16 v[96:99], v[32:35], v[8:11], v[96:99]
    v_perm_b32 v40, v200, v196, s33
    v_perm_b32 v41, v208, v204, s33
    v_perm_b32 v42, v216, v212, s33
    v_perm_b32 v43, v224, v220, s33
    v_mfma_f32_16x16x32_bf16 v[64:67], v[32:35], v[36:39], v[64:67]
    v_perm_b32 v36, v201, v197, s32
    v_perm_b32 v37, v209, v205, s32
    v_perm_b32 v38, v217, v213, s32
    v_perm_b32 v39, v225, v221, s32
    v_mfma_f32_16x16x32_bf16 v[68:71], v[32:35], v[40:43], v[68:71]
    v_perm_b32 v40, v201, v197, s33
    v_perm_b32 v41, v209, v205, s33
    v_perm_b32 v42, v217, v213, s33
    v_perm_b32 v43, v225, v221, s33
    v_mfma_f32_16x16x32_bf16 v[72:75], v[32:35], v[36:39], v[72:75]
    v_perm_b32 v36, v202, v198, s32
    v_perm_b32 v37, v210, v206, s32
    v_perm_b32 v38, v218, v214, s32
    v_perm_b32 v39, v226, v222, s32
    v_mfma_f32_16x16x32_bf16 v[76:79], v[32:35], v[40:43], v[76:79]
    v_perm_b32 v40, v202, v198, s33
    v_perm_b32 v41, v210, v206, s33
    v_perm_b32 v42, v218, v214, s33
    v_perm_b32 v43, v226, v222, s33
    v_mfma_f32_16x16x32_bf16 v[80:83], v[32:35], v[36:39], v[80:83]
    v_perm_b32 v36, v203, v199, s32
    v_perm_b32 v37, v211, v207, s32
    v_perm_b32 v38, v219, v215, s32
    v_perm_b32 v39, v227, v223, s32
    v_mfma_f32_16x16x32_bf16 v[84:87], v[32:35], v[40:43], v[84:87]
    v_perm_b32 v40, v203, v199, s33
    v_perm_b32 v41, v211, v207, s33
    v_perm_b32 v42, v219, v215, s33
    v_perm_b32 v43, v227, v223, s33
    v_mfma_f32_16x16x32_bf16 v[88:91], v[32:35], v[36:39], v[88:91]
    s_nop 0
    v_mfma_f32_16x16x32_bf16 v[92:95], v[32:35], v[40:43], v[92:95]
    s_waitcnt vmcnt(16)
    buffer_load_dwordx4 v[172:175], v2, s[12:15], s16 offen offset:2048 sc1 nt
    buffer_load_dwordx4 v[176:179], v2, s[12:15], s16 offen offset:3072 sc1 nt
    v_add_u32 v7, 2048, v7
    s_sub_u32 s18, s18, 1
    s_cmp_lg_u32 s18, 0
    s_cbranch_scc1 L_vloop2_standalone__linear_kernel_rfa__decode_kernel
    s_waitcnt vmcnt(16)
    ds_read_b64 v[48:49], v7 offset:0
    buffer_load_dwordx4 v[180:183], v3, s[12:15], s16 offen offset:0 sc1 nt
    buffer_load_dwordx4 v[184:187], v3, s[12:15], s16 offen offset:1024 sc1 nt
    s_waitcnt vmcnt(16)
    buffer_load_dwordx4 v[188:191], v3, s[12:15], s16 offen offset:2048 sc1 nt
    buffer_load_dwordx4 v[192:195], v3, s[12:15], s16 offen offset:3072 sc1 nt
    s_waitcnt lgkmcnt(0)
    v_cndmask_b32 v32, 0, v48, s[28:29]
    v_cndmask_b32 v33, 0, v49, s[28:29]
    v_cndmask_b32 v34, 0, v48, s[30:31]
    v_cndmask_b32 v35, 0, v49, s[30:31]
    s_nop 1
    v_permlane16_swap_b32 v32, v34
    v_permlane16_swap_b32 v33, v35
    s_waitcnt vmcnt(16)
    s_and_b32 s16, s17, 63
    s_lshl_b32 s16, s16, 15
    s_add_u32 s16, s16, s39
    s_xor_b32 s3, s17, s19
    s_and_b32 s3, s3, 1
    s_lshl_b32 s3, s3, 13
    s_add_u32 s16, s16, s3
    s_add_u32 s17, s17, 1
    buffer_load_dwordx4 v[196:199], v2, s[12:15], s16 offen offset:0 sc1 nt
    buffer_load_dwordx4 v[200:203], v2, s[12:15], s16 offen offset:1024 sc1 nt
    v_perm_b32 v36, v104, v100, s32
    v_perm_b32 v37, v112, v108, s32
    v_perm_b32 v38, v120, v116, s32
    v_perm_b32 v39, v128, v124, s32
    v_mfma_f32_16x16x32_bf16 v[96:99], v[32:35], v[8:11], v[96:99]
    v_perm_b32 v40, v104, v100, s33
    v_perm_b32 v41, v112, v108, s33
    v_perm_b32 v42, v120, v116, s33
    v_perm_b32 v43, v128, v124, s33
    v_mfma_f32_16x16x32_bf16 v[64:67], v[32:35], v[36:39], v[64:67]
    v_perm_b32 v36, v105, v101, s32
    v_perm_b32 v37, v113, v109, s32
    v_perm_b32 v38, v121, v117, s32
    v_perm_b32 v39, v129, v125, s32
    v_mfma_f32_16x16x32_bf16 v[68:71], v[32:35], v[40:43], v[68:71]
    v_perm_b32 v40, v105, v101, s33
    v_perm_b32 v41, v113, v109, s33
    v_perm_b32 v42, v121, v117, s33
    v_perm_b32 v43, v129, v125, s33
    v_mfma_f32_16x16x32_bf16 v[72:75], v[32:35], v[36:39], v[72:75]
    v_perm_b32 v36, v106, v102, s32
    v_perm_b32 v37, v114, v110, s32
    v_perm_b32 v38, v122, v118, s32
    v_perm_b32 v39, v130, v126, s32
    v_mfma_f32_16x16x32_bf16 v[76:79], v[32:35], v[40:43], v[76:79]
    v_perm_b32 v40, v106, v102, s33
    v_perm_b32 v41, v114, v110, s33
    v_perm_b32 v42, v122, v118, s33
    v_perm_b32 v43, v130, v126, s33
    v_mfma_f32_16x16x32_bf16 v[80:83], v[32:35], v[36:39], v[80:83]
    v_perm_b32 v36, v107, v103, s32
    v_perm_b32 v37, v115, v111, s32
    v_perm_b32 v38, v123, v119, s32
    v_perm_b32 v39, v131, v127, s32
    v_mfma_f32_16x16x32_bf16 v[84:87], v[32:35], v[40:43], v[84:87]
    v_perm_b32 v40, v107, v103, s33
    v_perm_b32 v41, v115, v111, s33
    v_perm_b32 v42, v123, v119, s33
    v_perm_b32 v43, v131, v127, s33
    v_mfma_f32_16x16x32_bf16 v[88:91], v[32:35], v[36:39], v[88:91]
    s_nop 0
    v_mfma_f32_16x16x32_bf16 v[92:95], v[32:35], v[40:43], v[92:95]
    s_waitcnt vmcnt(16)
    buffer_load_dwordx4 v[204:207], v2, s[12:15], s16 offen offset:2048 sc1 nt
    buffer_load_dwordx4 v[208:211], v2, s[12:15], s16 offen offset:3072 sc1 nt
    s_waitcnt vmcnt(16)
    ds_read_b64 v[48:49], v7 offset:512
    buffer_load_dwordx4 v[212:215], v3, s[12:15], s16 offen offset:0 sc1 nt
    buffer_load_dwordx4 v[216:219], v3, s[12:15], s16 offen offset:1024 sc1 nt
    v_mov_b32 v50, 1
    s_cmp_lg_u32 s19, 0
    s_cbranch_scc1 L_noticket_standalone__linear_kernel_rfa__decode_kernel
    s_lshl_b32 s3, s38, 4
    s_mov_b64 exec, 1
    buffer_atomic_add v50, off, s[44:47], s3 sc0
    s_mov_b64 exec, -1
L_noticket_standalone__linear_kernel_rfa__decode_kernel:
    s_waitcnt vmcnt(16)
    buffer_load_dwordx4 v[220:223], v3, s[12:15], s16 offen offset:2048 sc1 nt
    buffer_load_dwordx4 v[224:227], v3, s[12:15], s16 offen offset:3072 sc1 nt
    s_waitcnt lgkmcnt(0)
    v_cndmask_b32 v32, 0, v48, s[28:29]
    v_cndmask_b32 v33, 0, v49, s[28:29]
    v_cndmask_b32 v34, 0, v48, s[30:31]
    v_cndmask_b32 v35, 0, v49, s[30:31]
    s_nop 1
    v_permlane16_swap_b32 v32, v34
    v_permlane16_swap_b32 v33, v35
    s_waitcnt vmcnt(16)
    v_perm_b32 v36, v136, v132, s32
    v_perm_b32 v37, v144, v140, s32
    v_perm_b32 v38, v152, v148, s32
    v_perm_b32 v39, v160, v156, s32
    v_mfma_f32_16x16x32_bf16 v[96:99], v[32:35], v[8:11], v[96:99]
    v_perm_b32 v40, v136, v132, s33
    v_perm_b32 v41, v144, v140, s33
    v_perm_b32 v42, v152, v148, s33
    v_perm_b32 v43, v160, v156, s33
    v_mfma_f32_16x16x32_bf16 v[64:67], v[32:35], v[36:39], v[64:67]
    v_perm_b32 v36, v137, v133, s32
    v_perm_b32 v37, v145, v141, s32
    v_perm_b32 v38, v153, v149, s32
    v_perm_b32 v39, v161, v157, s32
    v_mfma_f32_16x16x32_bf16 v[68:71], v[32:35], v[40:43], v[68:71]
    v_perm_b32 v40, v137, v133, s33
    v_perm_b32 v41, v145, v141, s33
    v_perm_b32 v42, v153, v149, s33
    v_perm_b32 v43, v161, v157, s33
    v_mfma_f32_16x16x32_bf16 v[72:75], v[32:35], v[36:39], v[72:75]
    v_perm_b32 v36, v138, v134, s32
    v_perm_b32 v37, v146, v142, s32
    v_perm_b32 v38, v154, v150, s32
    v_perm_b32 v39, v162, v158, s32
    v_mfma_f32_16x16x32_bf16 v[76:79], v[32:35], v[40:43], v[76:79]
    v_perm_b32 v40, v138, v134, s33
    v_perm_b32 v41, v146, v142, s33
    v_perm_b32 v42, v154, v150, s33
    v_perm_b32 v43, v162, v158, s33
    v_mfma_f32_16x16x32_bf16 v[80:83], v[32:35], v[36:39], v[80:83]
    v_perm_b32 v36, v139, v135, s32
    v_perm_b32 v37, v147, v143, s32
    v_perm_b32 v38, v155, v151, s32
    v_perm_b32 v39, v163, v159, s32
    v_mfma_f32_16x16x32_bf16 v[84:87], v[32:35], v[40:43], v[84:87]
    v_perm_b32 v40, v139, v135, s33
    v_perm_b32 v41, v147, v143, s33
    v_perm_b32 v42, v155, v151, s33
    v_perm_b32 v43, v163, v159, s33
    v_mfma_f32_16x16x32_bf16 v[88:91], v[32:35], v[36:39], v[88:91]
    s_nop 0
    v_mfma_f32_16x16x32_bf16 v[92:95], v[32:35], v[40:43], v[92:95]
    ds_read_b64 v[48:49], v7 offset:1024
    s_waitcnt lgkmcnt(0)
    v_cndmask_b32 v32, 0, v48, s[28:29]
    v_cndmask_b32 v33, 0, v49, s[28:29]
    v_cndmask_b32 v34, 0, v48, s[30:31]
    v_cndmask_b32 v35, 0, v49, s[30:31]
    s_nop 1
    v_permlane16_swap_b32 v32, v34
    v_permlane16_swap_b32 v33, v35
    s_waitcnt vmcnt(8)
    v_perm_b32 v36, v168, v164, s32
    v_perm_b32 v37, v176, v172, s32
    v_perm_b32 v38, v184, v180, s32
    v_perm_b32 v39, v192, v188, s32
    v_mfma_f32_16x16x32_bf16 v[96:99], v[32:35], v[8:11], v[96:99]
    v_perm_b32 v40, v168, v164, s33
    v_perm_b32 v41, v176, v172, s33
    v_perm_b32 v42, v184, v180, s33
    v_perm_b32 v43, v192, v188, s33
    v_mfma_f32_16x16x32_bf16 v[64:67], v[32:35], v[36:39], v[64:67]
    v_perm_b32 v36, v169, v165, s32
    v_perm_b32 v37, v177, v173, s32
    v_perm_b32 v38, v185, v181, s32
    v_perm_b32 v39, v193, v189, s32
    v_mfma_f32_16x16x32_bf16 v[68:71], v[32:35], v[40:43], v[68:71]
    v_perm_b32 v40, v169, v165, s33
    v_perm_b32 v41, v177, v173, s33
    v_perm_b32 v42, v185, v181, s33
    v_perm_b32 v43, v193, v189, s33
    v_mfma_f32_16x16x32_bf16 v[72:75], v[32:35], v[36:39], v[72:75]
    v_perm_b32 v36, v170, v166, s32
    v_perm_b32 v37, v178, v174, s32
    v_perm_b32 v38, v186, v182, s32
    v_perm_b32 v39, v194, v190, s32
    v_mfma_f32_16x16x32_bf16 v[76:79], v[32:35], v[40:43], v[76:79]
    v_perm_b32 v40, v170, v166, s33
    v_perm_b32 v41, v178, v174, s33
    v_perm_b32 v42, v186, v182, s33
    v_perm_b32 v43, v194, v190, s33
    v_mfma_f32_16x16x32_bf16 v[80:83], v[32:35], v[36:39], v[80:83]
    v_perm_b32 v36, v171, v167, s32
    v_perm_b32 v37, v179, v175, s32
    v_perm_b32 v38, v187, v183, s32
    v_perm_b32 v39, v195, v191, s32
    v_mfma_f32_16x16x32_bf16 v[84:87], v[32:35], v[40:43], v[84:87]
    v_perm_b32 v40, v171, v167, s33
    v_perm_b32 v41, v179, v175, s33
    v_perm_b32 v42, v187, v183, s33
    v_perm_b32 v43, v195, v191, s33
    v_mfma_f32_16x16x32_bf16 v[88:91], v[32:35], v[36:39], v[88:91]
    s_nop 0
    v_mfma_f32_16x16x32_bf16 v[92:95], v[32:35], v[40:43], v[92:95]
    ds_read_b64 v[48:49], v7 offset:1536
    s_waitcnt lgkmcnt(0)
    v_cndmask_b32 v32, 0, v48, s[28:29]
    v_cndmask_b32 v33, 0, v49, s[28:29]
    v_cndmask_b32 v34, 0, v48, s[30:31]
    v_cndmask_b32 v35, 0, v49, s[30:31]
    s_nop 1
    v_permlane16_swap_b32 v32, v34
    v_permlane16_swap_b32 v33, v35
    s_waitcnt vmcnt(0)
    v_readfirstlane_b32 s61, v50
    v_and_b32 v26, 16, v6
    v_and_b32 v27, 15, v6
    v_lshl_add_u32 v31, v27, 5, v26
    s_cmp_lg_u32 s61, 15
    s_cbranch_scc1 L_nopoll_standalone__linear_kernel_rfa__decode_kernel
    s_lshl_b32 s17, s38, 9
    s_add_u32 s17, s17, 1048576
    s_lshl_b32 s16, s38, 14
    buffer_load_dwordx4 v[16:19], v31, s[40:43], s17 offen sc1
    buffer_load_dwordx4 v[100:103], v2, s[40:43], s16 offen offset:0 sc1
    buffer_load_dwordx4 v[104:107], v2, s[40:43], s16 offen offset:1024 sc1
    buffer_load_dwordx4 v[108:111], v2, s[40:43], s16 offen offset:2048 sc1
    buffer_load_dwordx4 v[112:115], v2, s[40:43], s16 offen offset:3072 sc1
    s_add_u32 s16, s16, 4096
    buffer_load_dwordx4 v[116:119], v2, s[40:43], s16 offen offset:0 sc1
    buffer_load_dwordx4 v[120:123], v2, s[40:43], s16 offen offset:1024 sc1
    buffer_load_dwordx4 v[124:127], v2, s[40:43], s16 offen offset:2048 sc1
    buffer_load_dwordx4 v[128:131], v2, s[40:43], s16 offen offset:3072 sc1
    s_add_u32 s16, s16, 4096
    buffer_load_dwordx4 v[132:135], v2, s[40:43], s16 offen offset:0 sc1
    buffer_load_dwordx4 v[136:139], v2, s[40:43], s16 offen offset:1024 sc1
    buffer_load_dwordx4 v[140:143], v2, s[40:43], s16 offen offset:2048 sc1
    buffer_load_dwordx4 v[144:147], v2, s[40:43], s16 offen offset:3072 sc1
    s_add_u32 s16, s16, 4096
    buffer_load_dwordx4 v[148:151], v2, s[40:43], s16 offen offset:0 sc1
    buffer_load_dwordx4 v[152:155], v2, s[40:43], s16 offen offset:1024 sc1
    buffer_load_dwordx4 v[156:159], v2, s[40:43], s16 offen offset:2048 sc1
    buffer_load_dwordx4 v[160:163], v2, s[40:43], s16 offen offset:3072 sc1
L_nopoll_standalone__linear_kernel_rfa__decode_kernel:
    v_perm_b32 v36, v200, v196, s32
    v_perm_b32 v37, v208, v204, s32
    v_perm_b32 v38, v216, v212, s32
    v_perm_b32 v39, v224, v220, s32
    v_mfma_f32_16x16x32_bf16 v[96:99], v[32:35], v[8:11], v[96:99]
    v_perm_b32 v40, v200, v196, s33
    v_perm_b32 v41, v208, v204, s33
    v_perm_b32 v42, v216, v212, s33
    v_perm_b32 v43, v224, v220, s33
    v_mfma_f32_16x16x32_bf16 v[64:67], v[32:35], v[36:39], v[64:67]
    v_perm_b32 v36, v201, v197, s32
    v_perm_b32 v37, v209, v205, s32
    v_perm_b32 v38, v217, v213, s32
    v_perm_b32 v39, v225, v221, s32
    v_mfma_f32_16x16x32_bf16 v[68:71], v[32:35], v[40:43], v[68:71]
    v_perm_b32 v40, v201, v197, s33
    v_perm_b32 v41, v209, v205, s33
    v_perm_b32 v42, v217, v213, s33
    v_perm_b32 v43, v225, v221, s33
    v_mfma_f32_16x16x32_bf16 v[72:75], v[32:35], v[36:39], v[72:75]
    v_perm_b32 v36, v202, v198, s32
    v_perm_b32 v37, v210, v206, s32
    v_perm_b32 v38, v218, v214, s32
    v_perm_b32 v39, v226, v222, s32
    v_mfma_f32_16x16x32_bf16 v[76:79], v[32:35], v[40:43], v[76:79]
    v_perm_b32 v40, v202, v198, s33
    v_perm_b32 v41, v210, v206, s33
    v_perm_b32 v42, v218, v214, s33
    v_perm_b32 v43, v226, v222, s33
    v_mfma_f32_16x16x32_bf16 v[80:83], v[32:35], v[36:39], v[80:83]
    v_perm_b32 v36, v203, v199, s32
    v_perm_b32 v37, v211, v207, s32
    v_perm_b32 v38, v219, v215, s32
    v_perm_b32 v39, v227, v223, s32
    v_mfma_f32_16x16x32_bf16 v[84:87], v[32:35], v[40:43], v[84:87]
    v_perm_b32 v40, v203, v199, s33
    v_perm_b32 v41, v211, v207, s33
    v_perm_b32 v42, v219, v215, s33
    v_perm_b32 v43, v227, v223, s33
    v_mfma_f32_16x16x32_bf16 v[88:91], v[32:35], v[36:39], v[88:91]
    s_nop 0
    v_mfma_f32_16x16x32_bf16 v[92:95], v[32:35], v[40:43], v[92:95]
    s_lshl_b32 s16, s2, 10
    s_lshl_b32 s17, s2, 5
    s_add_u32 s17, s17, 1048576
    v_and_b32 v26, 16, v6
    v_mul_f32 v164, v44, v64
    v_fmac_f32 v164, v45, v65
    v_fmac_f32 v164, v46, v66
    v_fmac_f32 v164, v47, v67
    v_mul_f32 v165, v44, v68
    v_fmac_f32 v165, v45, v69
    v_fmac_f32 v165, v46, v70
    v_fmac_f32 v165, v47, v71
    v_mul_f32 v166, v44, v72
    v_fmac_f32 v166, v45, v73
    v_fmac_f32 v166, v46, v74
    v_fmac_f32 v166, v47, v75
    v_mul_f32 v167, v44, v76
    v_fmac_f32 v167, v45, v77
    v_fmac_f32 v167, v46, v78
    v_fmac_f32 v167, v47, v79
    v_mul_f32 v168, v44, v80
    v_fmac_f32 v168, v45, v81
    v_fmac_f32 v168, v46, v82
    v_fmac_f32 v168, v47, v83
    v_mul_f32 v169, v44, v84
    v_fmac_f32 v169, v45, v85
    v_fmac_f32 v169, v46, v86
    v_fmac_f32 v169, v47, v87
    v_mul_f32 v170, v44, v88
    v_fmac_f32 v170, v45, v89
    v_fmac_f32 v170, v46, v90
    v_fmac_f32 v170, v47, v91
    v_mul_f32 v171, v44, v92
    v_fmac_f32 v171, v45, v93
    v_fmac_f32 v171, v46, v94
    v_fmac_f32 v171, v47, v95
    v_permlane16_swap_b32 v164, v168
    v_permlane16_swap_b32 v165, v169
    v_permlane16_swap_b32 v166, v170
    v_permlane16_swap_b32 v167, v171
    v_pk_add_f32 v[164:165], v[164:165], v[168:169]
    v_pk_add_f32 v[166:167], v[166:167], v[170:171]
    s_cmp_eq_u32 s19, 0
    s_cbranch_scc1 L_w0_standalone__linear_kernel_rfa__decode_kernel
    v_add_u32 v24, s60, v2
    ds_write_b128 v24, v[164:167]
    ds_write_b128 v24, v[96:99] offset:1024
    s_waitcnt lgkmcnt(0)
    s_barrier
    s_branch L_fin_standalone__linear_kernel_rfa__decode_kernel
L_w0_standalone__linear_kernel_rfa__decode_kernel:
    s_barrier
    ds_read_b128 v[172:175], v2 offset:32768
    ds_read_b128 v[176:179], v2 offset:33792
    s_waitcnt lgkmcnt(0)
    v_pk_add_f32 v[164:165], v[164:165], v[172:173]
    v_pk_add_f32 v[166:167], v[166:167], v[174:175]
    v_pk_add_f32 v[96:97], v[96:97], v[176:177]
    v_pk_add_f32 v[98:99], v[98:99], v[178:179]
    s_mov_b32 s3, 0xfffffffe
    v_min_u32 v164, s3, v164
    v_min_u32 v165, s3, v165
    v_min_u32 v166, s3, v166
    v_min_u32 v167, s3, v167
    v_min_u32 v96, s3, v96
    v_min_u32 v97, s3, v97
    v_min_u32 v98, s3, v98
    v_min_u32 v99, s3, v99
    s_cmp_eq_u32 s61, 15
    s_cbranch_scc1 L_last_standalone__linear_kernel_rfa__decode_kernel
    buffer_store_dwordx4 v[164:167], v2, s[40:43], s16 offen sc1
    s_mov_b64 exec, 0x10001
    buffer_store_dwordx4 v[96:99], v26, s[40:43], s17 offen sc1
    s_mov_b64 exec, -1
    s_branch L_fin_standalone__linear_kernel_rfa__decode_kernel
L_last_standalone__linear_kernel_rfa__decode_kernel:
    s_and_b32 s3, s2, 15
    v_cmp_eq_u32 s[20:21], s3, v27
    s_lshl_b32 s60, s3, 2
    v_lshlrev_b32 v28, 4, v27
    v_lshrrev_b32 v29, 5, v6
    v_lshlrev_b32 v29, 8, v29
    v_bfe_u32 v30, v6, 4, 1
    v_lshlrev_b32 v30, 3, v30
    v_add3_u32 v28, v28, v29, v30
    s_lshl_b32 s18, s38, 9
    s_mov_b32 s39, 1048576
L_look_standalone__linear_kernel_rfa__decode_kernel:
    s_waitcnt vmcnt(16)
    v_cndmask_b32 v16, v16, v96, s[20:21]
    v_cndmask_b32 v17, v17, v97, s[20:21]
    v_cndmask_b32 v18, v18, v98, s[20:21]
    v_cndmask_b32 v19, v19, v99, s[20:21]
    v_max3_u32 v24, v16, v17, v18
    v_max_u32 v24, v24, v19
    v_cmp_eq_u32 vcc, -1, v24
    s_cbranch_vccnz L_again_standalone__linear_kernel_rfa__decode_kernel
L_goon_standalone__linear_kernel_rfa__decode_kernel:
    v_add_f32_dpp v12, v16, v16 row_ror:8 row_mask:0xf bank_mask:0xf
    v_add_f32_dpp v13, v17, v17 row_ror:8 row_mask:0xf bank_mask:0xf
    v_add_f32_dpp v14, v18, v18 row_ror:8 row_mask:0xf bank_mask:0xf
    v_add_f32_dpp v15, v19, v19 row_ror:8 row_mask:0xf bank_mask:0xf
    v_add_f32_dpp v12, v12, v12 row_ror:4 row_mask:0xf bank_mask:0xf
    v_add_f32_dpp v13, v13, v13 row_ror:4 row_mask:0xf bank_mask:0xf
    v_add_f32_dpp v14, v14, v14 row_ror:4 row_mask:0xf bank_mask:0xf
    v_add_f32_dpp v15, v15, v15 row_ror:4 row_mask:0xf bank_mask:0xf
    v_add_f32_dpp v12, v12, v12 row_ror:2 row_mask:0xf bank_mask:0xf
    v_add_f32_dpp v13, v13, v13 row_ror:2 row_mask:0xf bank_mask:0xf
    v_add_f32_dpp v14, v14, v14 row_ror:2 row_mask:0xf bank_mask:0xf
    v_add_f32_dpp v15, v15, v15 row_ror:2 row_mask:0xf bank_mask:0xf
    v_add_f32_dpp v12, v12, v12 row_ror:1 row_mask:0xf bank_mask:0xf
    v_add_f32_dpp v13, v13, v13 row_ror:1 row_mask:0xf bank_mask:0xf
    v_add_f32_dpp v14, v14, v14 row_ror:1 row_mask:0xf bank_mask:0xf
    v_add_f32_dpp v15, v15, v15 row_ror:1 row_mask:0xf bank_mask:0xf
    v_cvt_pk_bf16_f32 v24, v12, v13
    v_cvt_pk_bf16_f32 v25, v14, v15
    v_lshlrev_b32 v12, 16, v24
    v_and_b32 v13, 0xffff0000, v24
    v_lshlrev_b32 v14, 16, v25
    v_and_b32 v15, 0xffff0000, v25
    v_mul_f32 v20, v44, v12
    v_fmac_f32 v20, v45, v13
    v_fmac_f32 v20, v46, v14
    v_fmac_f32 v20, v47, v15
    v_mov_b32 v24, v20
    s_nop 1
    v_permlane16_swap_b32 v20, v24
    v_add_f32 v20, v20, v24
    v_cvt_pk_bf16_f32 v20, v20, v20
    v_and_b32 v20, 0xffff0000, v20
    v_add_f32 v20, s36, v20
    v_cvt_pk_bf16_f32 v20, v20, v20
    v_and_b32 v20, 0xffff0000, v20
    v_frexp_mant_f32 v21, v20
    v_frexp_exp_i32_f32 v22, v20
    v_rcp_f32 v21, v21
    v_sub_u32 v22, 0, v22
    s_waitcnt vmcnt(0)
    s_set_gpr_idx_on s60, gpr_idx(DST)
    v_mov_b32 v100, v164
    v_mov_b32 v101, v165
    v_mov_b32 v102, v166
    v_mov_b32 v103, v167
    s_set_gpr_idx_off
    v_pk_add_f32 v[64:65], v[100:101], v[104:105]
    v_pk_add_f32 v[66:67], v[102:103], v[106:107]
    v_pk_add_f32 v[68:69], v[108:109], v[112:113]
    v_pk_add_f32 v[70:71], v[110:111], v[114:115]
    v_pk_add_f32 v[72:73], v[116:117], v[120:121]
    v_pk_add_f32 v[74:75], v[118:119], v[122:123]
    v_pk_add_f32 v[76:77], v[124:125], v[128:129]
    v_pk_add_f32 v[78:79], v[126:127], v[130:131]
    v_pk_add_f32 v[80:81], v[132:133], v[136:137]
    v_pk_add_f32 v[82:83], v[134:135], v[138:139]
    v_pk_add_f32 v[84:85], v[140:141], v[144:145]
    v_pk_add_f32 v[86:87], v[142:143], v[146:147]
    v_pk_add_f32 v[88:89], v[148:149], v[152:153]
    v_pk_add_f32 v[90:91], v[150:151], v[154:155]
    v_pk_add_f32 v[92:93], v[156:157], v[160:161]
    v_pk_add_f32 v[94:95], v[158:159], v[162:163]
    v_pk_add_f32 v[64:65], v[64:65], v[68:69]
    v_pk_add_f32 v[66:67], v[66:67], v[70:71]
    v_pk_add_f32 v[72:73], v[72:73], v[76:77]
    v_pk_add_f32 v[74:75], v[74:75], v[78:79]
    v_pk_add_f32 v[80:81], v[80:81], v[84:85]
    v_pk_add_f32 v[82:83], v[82:83], v[86:87]
    v_pk_add_f32 v[88:89], v[88:89], v[92:93]
    v_pk_add_f32 v[90:91], v[90:91], v[94:95]
    v_pk_add_f32 v[64:65], v[64:65], v[72:73]
    v_pk_add_f32 v[66:67], v[66:67], v[74:75]
    v_pk_add_f32 v[80:81], v[80:81], v[88:89]
    v_pk_add_f32 v[82:83], v[82:83], v[90:91]
    v_pk_add_f32 v[64:65], v[64:65], v[80:81]
    v_pk_add_f32 v[66:67], v[66:67], v[82:83]
    v_cmp_u_f32 s[22:23], v64, v65
    v_cmp_u_f32 s[24:25], v66, v67
    v_cmp_u_f32 vcc, v20, v20
    v_cvt_pk_bf16_f32 v24, v64, v65
    v_cvt_pk_bf16_f32 v25, v66, v67
    v_lshlrev_b32 v64, 16, v24
    v_and_b32 v65, 0xffff0000, v24
    v_lshlrev_b32 v66, 16, v25
    v_and_b32 v67, 0xffff0000, v25
    s_or_b64 vcc, vcc, s[22:23]
    s_or_b64 vcc, vcc, s[24:25]
    s_cbranch_scc1 L_nan_standalone__linear_kernel_rfa__decode_kernel
L_out_standalone__linear_kernel_rfa__decode_kernel:
    v_ldexp_f32 v64, v64, v22
    v_ldexp_f32 v65, v65, v22
    v_ldexp_f32 v66, v66, v22
    v_ldexp_f32 v67, v67, v22
    v_mul_f32 v64, v64, v21
    v_mul_f32 v65, v65, v21
    v_mul_f32 v66, v66, v21
    v_mul_f32 v67, v67, v21
    v_cvt_pk_bf16_f32 v64, v64, v65
    v_cvt_pk_bf16_f32 v65, v66, v67
    buffer_store_dwordx2 v[64:65], v28, s[4:7], s18 offen
    s_branch L_fin_standalone__linear_kernel_rfa__decode_kernel
L_nan_standalone__linear_kernel_rfa__decode_kernel:
    v_max_u32 v24, v100, v101
    v_max3_u32 v24, v24, v102, v103
    v_max3_u32 v24, v24, v104, v105
    v_max3_u32 v24, v24, v106, v107
    v_max3_u32 v24, v24, v108, v109
    v_max3_u32 v24, v24, v110, v111
    v_max3_u32 v24, v24, v112, v113
    v_max3_u32 v24, v24, v114, v115
    v_max3_u32 v24, v24, v116, v117
    v_max3_u32 v24, v24, v118, v119
    v_max3_u32 v24, v24, v120, v121
    v_max3_u32 v24, v24, v122, v123
    v_max3_u32 v24, v24, v124, v125
    v_max3_u32 v24, v24, v126, v127
    v_max3_u32 v24, v24, v128, v129
    v_max3_u32 v24, v24, v130, v131
    v_max3_u32 v24, v24, v132, v133
    v_max3_u32 v24, v24, v134, v135
    v_max3_u32 v24, v24, v136, v137
    v_max3_u32 v24, v24, v138, v139
    v_max3_u32 v24, v24, v140, v141
    v_max3_u32 v24, v24, v142, v143
    v_max3_u32 v24, v24, v144, v145
    v_max3_u32 v24, v24, v146, v147
    v_max3_u32 v24, v24, v148, v149
    v_max3_u32 v24, v24, v150, v151
    v_max3_u32 v24, v24, v152, v153
    v_max3_u32 v24, v24, v154, v155
    v_max3_u32 v24, v24, v156, v157
    v_max3_u32 v24, v24, v158, v159
    v_max3_u32 v24, v24, v160, v161
    v_max3_u32 v24, v24, v162, v163
    v_max3_u32 v24, v24, v16, v17
    v_max3_u32 v24, v24, v18, v19
    v_cmp_eq_u32 vcc, -1, v24
    s_cmp_eq_u32 s39, 0
    s_cbranch_scc1 L_out_standalone__linear_kernel_rfa__decode_kernel
    s_cbranch_vccz L_out_standalone__linear_kernel_rfa__decode_kernel
L_again_standalone__linear_kernel_rfa__decode_kernel:
    s_cmp_eq_u32 s39, 0
    s_cbranch_scc1 L_goon_standalone__linear_kernel_rfa__decode_kernel
    s_sub_u32 s39, s39, 1
    s_lshl_b32 s17, s38, 9
    s_add_u32 s17, s17, 1048576
    s_lshl_b32 s16, s38, 14
    buffer_load_dwordx4 v[16:19], v31, s[40:43], s17 offen sc1
    buffer_load_dwordx4 v[100:103], v2, s[40:43], s16 offen offset:0 sc1
    buffer_load_dwordx4 v[104:107], v2, s[40:43], s16 offen offset:1024 sc1
    buffer_load_dwordx4 v[108:111], v2, s[40:43], s16 offen offset:2048 sc1
    buffer_load_dwordx4 v[112:115], v2, s[40:43], s16 offen offset:3072 sc1
    s_add_u32 s16, s16, 4096
    buffer_load_dwordx4 v[116:119], v2, s[40:43], s16 offen offset:0 sc1
    buffer_load_dwordx4 v[120:123], v2, s[40:43], s16 offen offset:1024 sc1
    buffer_load_dwordx4 v[124:127], v2, s[40:43], s16 offen offset:2048 sc1
    buffer_load_dwordx4 v[128:131], v2, s[40:43], s16 offen offset:3072 sc1
    s_add_u32 s16, s16, 4096
    buffer_load_dwordx4 v[132:135], v2, s[40:43], s16 offen offset:0 sc1
    buffer_load_dwordx4 v[136:139], v2, s[40:43], s16 offen offset:1024 sc1
    buffer_load_dwordx4 v[140:143], v2, s[40:43], s16 offen offset:2048 sc1
    buffer_load_dwordx4 v[144:147], v2, s[40:43], s16 offen offset:3072 sc1
    s_add_u32 s16, s16, 4096
    buffer_load_dwordx4 v[148:151], v2, s[40:43], s16 offen offset:0 sc1
    buffer_load_dwordx4 v[152:155], v2, s[40:43], s16 offen offset:1024 sc1
    buffer_load_dwordx4 v[156:159], v2, s[40:43], s16 offen offset:2048 sc1
    buffer_load_dwordx4 v[160:163], v2, s[40:43], s16 offen offset:3072 sc1
    s_branch L_look_standalone__linear_kernel_rfa__decode_kernel
L_fin_standalone__linear_kernel_rfa__decode_kernel:
L_end_standalone__linear_kernel_rfa__decode_kernel:
    s_endpgm
.section .rodata,"a"
.p2align 6
.amdhsa_kernel standalone__linear_kernel_rfa__decode_kernel
  .amdhsa_next_free_vgpr 324
  .amdhsa_next_free_sgpr 64
  .amdhsa_accum_offset 228
  .amdhsa_group_segment_fixed_size 0
  .amdhsa_kernarg_size 56
  .amdhsa_user_sgpr_count 2
  .amdhsa_user_sgpr_kernarg_segment_ptr 1
  .amdhsa_system_sgpr_workgroup_id_x 1
  .amdhsa_float_denorm_mode_32 3
.end_amdhsa_kernel
```
